```python
import torch

def _softmax(x, axis=-1):
    return torch.softmax(x, dim=axis)
def _gelu(x):
    return torch.nn.functional.gelu(x, approximate="tanh")
def _silu(x):
    return torch.nn.functional.silu(x)
def _sigmoid(x):
    return torch.sigmoid(x)
def _layernorm(x, axis=-1, eps=1e-5):
    m = x.mean(dim=axis, keepdim=True)
    v = x.var(dim=axis, keepdim=True, unbiased=False)
    return (x - m) / torch.sqrt(v + eps)
def _scatter_add(tgt, idx, src, axis=0):
    return tgt.clone().index_add_(axis, idx, src)
def _segment_sum(src, seg, n):
    out = torch.zeros((n,) + src.shape[1:], dtype=src.dtype)
    return out.index_add_(0, seg, src)
def _pad(x, pw):
    flat = tuple(v for pair in reversed(pw) for v in pair)
    return torch.nn.functional.pad(x, flat)

kernel_name = 'sequential_preLN__gqa_block_cached__mixer_token_mlp__decode'

def setup_inputs():

    _w = (lambda a: (lambda t: t.to(torch.bfloat16) if t.is_floating_point() else t)(torch.as_tensor(a)))
    def _A_setup():
        B, Sq, D = 8, 1, 448
        Hq, Hkv, Sk, Dh = 16, 8, 8192, 256
        assert Hq % Hkv == 0, (Hq, Hkv)
        return {
            "x": _w((lambda *s: torch.randn(*s, dtype=torch.bfloat16) * 0.05)(B, Sq, D)),
            "k_cache": _w((lambda *s: torch.randn(*s, dtype=torch.bfloat16) * 1.6)(B, Hkv, Sk, Dh)),
            "v_cache": _w((lambda *s: torch.randn(*s, dtype=torch.bfloat16) * 0.8)(B, Hkv, Sk, Dh)),
            "wq": _w((lambda *s: torch.randn(*s, dtype=torch.bfloat16) * 1.6)(D, Hq * Dh) * (D ** -0.5)),
            "wo": _w((lambda *s: torch.randn(*s, dtype=torch.bfloat16) * 0.8)(Hq * Dh, D) * ((Hq * Dh) ** -0.5)),
        }
    _A_in = _A_setup()

    def _B_setup():
        B, S, D, F = 8, 1, 448, 1792
        return {
            "x": _w((lambda *s: torch.randn(*s, dtype=torch.bfloat16) * 0.05)(B, S, D)),
            "w1": _w((lambda *s: torch.randn(*s, dtype=torch.bfloat16) * 0.4)(S, F) * (S ** -0.5)),
            "b1": _w((lambda *s: torch.randn(*s, dtype=torch.bfloat16) * 0.4)(F) * 0.02),
            "w2": _w((lambda *s: torch.randn(*s, dtype=torch.bfloat16) * 0.4)(F, S) * (F ** -0.5)),
            "b2": _w((lambda *s: torch.randn(*s, dtype=torch.bfloat16) * 0.4)(S) * 0.02),
        }
    _B_in = _B_setup()

    return {
        "A_x": _A_in["x"],
        "A_k_cache": _A_in["k_cache"],
        "A_v_cache": _A_in["v_cache"],
        "A_wq": _A_in["wq"],
        "A_wo": _A_in["wo"],
        "B_x": _B_in["x"],
        "B_w1": _B_in["w1"],
        "B_b1": _B_in["b1"],
        "B_w2": _B_in["w2"],
        "B_b2": _B_in["b2"],
    }

def reference(A_x, A_k_cache, A_v_cache, A_wq, A_wo, B_x, B_w1, B_b1, B_w2, B_b2):
    def _A_ref(x, k_cache, v_cache, wq, wo):
        B, Sq, D = x.shape
        Hq, Dh = 16, 256
        Hkv = k_cache.shape[1]
        rep = Hq // Hkv
        q = (lambda x, *d: x.permute(*d))((x @ wq).reshape(B, Sq, Hq, Dh), 0, 2, 1, 3)
        k = (lambda x, n, axis: torch.repeat_interleave(x, n, dim=axis))(k_cache, rep, axis=1)
        v = (lambda x, n, axis: torch.repeat_interleave(x, n, dim=axis))(v_cache, rep, axis=1)
        scores = torch.einsum("bhqd,bhkd->bhqk", q, k) * (Dh ** -0.5)
        p = _softmax(scores, axis=-1)
        o = torch.einsum("bhqk,bhkd->bhqd", p, v)
        return (lambda x, *d: x.permute(*d))(o, 0, 2, 1, 3).reshape(B, Sq, Hq * Dh) @ wo

    def _B_ref(x, w1, b1, w2, b2):
        B, S, D = x.shape
        h = _layernorm(x, axis=-1)
        u = torch.einsum("bsd,sf->bdf", h, w1) + b1
        u = _gelu(u)
        y = torch.einsum("bdf,fs->bds", u, w2) + b2
        return (lambda x, *d: x.permute(*d))(y, 0, 2, 1)

    x = A_x
    h = x + _A_ref(_layernorm(x, axis=-1), A_k_cache, A_v_cache, A_wq, A_wo)
    h2 = h + _B_ref(_layernorm(h, axis=-1), B_w1, B_b1, B_w2, B_b2)
    return h2
```

```asm
; @launch grid=(256,1,1) block=(512,1,1) lds=163840
.amdgcn_target "amdgcn-amd-amdhsa--gfx950"
.text
.globl sequential_preLN__gqa_block_cached__mixer_token_mlp__decode_kernel
.p2align 8
.type sequential_preLN__gqa_block_cached__mixer_token_mlp__decode_kernel,@function
sequential_preLN__gqa_block_cached__mixer_token_mlp__decode_kernel:
    s_cmp_ge_u32 s2, 256
    s_cbranch_scc1 L_done
    s_load_dwordx16 s[16:31], s[0:1], 0
    s_load_dwordx8 s[32:39], s[0:1], 64
    s_load_dwordx2 s[40:41], s[0:1], 96
    v_lshrrev_b32 v1, 6, v0
    v_and_b32 v2, 63, v0
    v_and_b32 v3, 15, v2
    v_readfirstlane_b32 s3, v1
    v_lshrrev_b32 v4, 4, v2
    s_lshr_b32 s4, s2, 5
    s_and_b32 s5, s2, 31
    s_lshr_b32 s96, s5, 2
    s_and_b32 s97, s5, 3
    s_lshl_b32 s98, s4, 5
    s_add_u32 s98, s98, s5
    v_cmp_gt_u32 s[56:57], 56, v2
    s_mov_b64 s[58:59], exec
    s_waitcnt lgkmcnt(0)
    s_mov_b32 s60, s16
    s_and_b32 s61, s17, 0xffff
    s_mov_b32 s62, 7168
    s_mov_b32 s63, 0x00020000
    s_mov_b32 s64, s22
    s_and_b32 s65, s23, 0xffff
    s_mov_b32 s66, 3670016
    s_mov_b32 s67, 0x00020000
    s_mov_b32 s72, s38
    s_and_b32 s73, s39, 0xffff
    s_mov_b32 s74, 256
    s_mov_b32 s75, 0x00020000
    s_and_b32 s38, s5, 7
    s_lshl_b32 s38, s38, 2
    s_lshr_b32 s39, s5, 3
    s_add_u32 s38, s38, s39
    s_lshl_b32 s39, s4, 5
    s_add_u32 s39, s39, s38
    s_cmp_lt_u32 s3, 4
    s_cbranch_scc1 L_stream
L_helpers:
    s_memrealtime s[16:17]
    v_lshlrev_b32 v5, 4, v2
    v_mov_b32 v6, 0x7fff0000
    v_cndmask_b32 v5, v6, v5, s[56:57]
    s_sub_u32 s6, s3, 4
    s_mul_i32 s15, s6, 1792
    buffer_load_dwordx4 v[8:11], v5, s[60:63], s15 offen
    buffer_load_dwordx4 v[12:15], v5, s[60:63], s15 offen offset:896
    s_cmp_lg_u32 s3, 4
    s_cbranch_scc1 L_h_nowq
    v_lshrrev_b32 v5, 1, v2
    v_lshlrev_b32 v5, 13, v5
    v_and_b32 v6, 1, v2
    v_lshl_add_u32 v5, v6, 4, v5
    s_lshl_b32 s6, s39, 5
    s_mov_b32 s7, 131072
    s_mov_b32 m0, s7
    s_add_u32 s7, s7, 1024
    buffer_load_dwordx4 v5, s[64:67], s6 offen lds
    s_add_u32 s6, s6, 0x40000
    s_mov_b32 m0, s7
    s_add_u32 s7, s7, 1024
    buffer_load_dwordx4 v5, s[64:67], s6 offen lds
    s_add_u32 s6, s6, 0x40000
    s_mov_b32 m0, s7
    s_add_u32 s7, s7, 1024
    buffer_load_dwordx4 v5, s[64:67], s6 offen lds
    s_add_u32 s6, s6, 0x40000
    s_mov_b32 m0, s7
    s_add_u32 s7, s7, 1024
    buffer_load_dwordx4 v5, s[64:67], s6 offen lds
    s_add_u32 s6, s6, 0x40000
    s_mov_b32 m0, s7
    s_add_u32 s7, s7, 1024
    buffer_load_dwordx4 v5, s[64:67], s6 offen lds
    s_add_u32 s6, s6, 0x40000
    s_mov_b32 m0, s7
    s_add_u32 s7, s7, 1024
    buffer_load_dwordx4 v5, s[64:67], s6 offen lds
    s_add_u32 s6, s6, 0x40000
    s_mov_b32 m0, s7
    s_add_u32 s7, s7, 1024
    buffer_load_dwordx4 v5, s[64:67], s6 offen lds
    s_add_u32 s6, s6, 0x40000
    s_mov_b32 m0, s7
    s_add_u32 s7, s7, 1024
    buffer_load_dwordx4 v5, s[64:67], s6 offen lds
    s_add_u32 s6, s6, 0x40000
    s_mov_b32 m0, s7
    s_add_u32 s7, s7, 1024
    buffer_load_dwordx4 v5, s[64:67], s6 offen lds
    s_add_u32 s6, s6, 0x40000
    s_mov_b32 m0, s7
    s_add_u32 s7, s7, 1024
    buffer_load_dwordx4 v5, s[64:67], s6 offen lds
    s_add_u32 s6, s6, 0x40000
    s_mov_b32 m0, s7
    s_add_u32 s7, s7, 1024
    buffer_load_dwordx4 v5, s[64:67], s6 offen lds
    s_add_u32 s6, s6, 0x40000
    s_mov_b32 m0, s7
    s_add_u32 s7, s7, 1024
    buffer_load_dwordx4 v5, s[64:67], s6 offen lds
    s_add_u32 s6, s6, 0x40000
    s_mov_b32 m0, s7
    s_add_u32 s7, s7, 1024
    buffer_load_dwordx4 v5, s[64:67], s6 offen lds
    s_add_u32 s6, s6, 0x40000
    s_mov_b32 m0, s7
    s_add_u32 s7, s7, 1024
    buffer_load_dwordx4 v5, s[64:67], s6 offen lds
    s_add_u32 s6, s6, 0x40000
L_h_nowq:
    s_mov_b32 s44, s18
    s_and_b32 s45, s19, 0xffff
    s_mov_b32 s46, 268435456
    s_mov_b32 s47, 0x00020000
    s_mov_b32 s48, s20
    s_and_b32 s49, s21, 0xffff
    s_mov_b32 s50, 268435456
    s_mov_b32 s51, 0x00020000
    s_mov_b32 s52, s40
    s_and_b32 s53, s41, 0xffff
    s_mov_b32 s54, 4194304
    s_mov_b32 s55, 0x00020000
    s_mov_b32 s68, s24
    s_and_b32 s69, s25, 0xffff
    s_mov_b32 s70, 3670016
    s_mov_b32 s71, 0x00020000
    s_mov_b32 s76, s36
    s_and_b32 s77, s37, 0xffff
    s_mov_b32 s78, 7168
    s_mov_b32 s79, 0x00020000
    s_mov_b32 s80, s28
    s_and_b32 s81, s29, 0xffff
    s_mov_b32 s82, 3584
    s_mov_b32 s83, 0x00020000
    s_mov_b32 s84, s30
    s_and_b32 s85, s31, 0xffff
    s_mov_b32 s86, 3584
    s_mov_b32 s87, 0x00020000
    s_mov_b32 s88, s32
    s_and_b32 s89, s33, 0xffff
    s_mov_b32 s90, 3584
    s_mov_b32 s91, 0x00020000
    s_mov_b32 s92, s34
    s_and_b32 s93, s35, 0xffff
    s_mov_b32 s94, 4
    s_mov_b32 s95, 0x00020000
    s_cmp_ge_u32 s38, 14
    s_cselect_b32 s99, 1, 0
    s_mul_i32 s6, s99, 14
    s_sub_u32 s100, s38, s6
    s_lshl_b32 s101, s4, 1
    s_add_u32 s101, s101, s99
    s_cmp_lg_u32 s3, 4
    s_cbranch_scc1 L_h_not4
    v_mov_b32 v5, 162816
    v_mov_b32 v16, 0
    v_mov_b32 v17, 0
    v_mov_b32 v18, 0
    v_mov_b32 v19, 0
    ds_write_b128 v5, v[16:19]
    s_mul_i32 s6, s97, 24
    v_add_u32 v16, s6, v2
    v_cmp_gt_u32 vcc, 24, v2
    v_lshlrev_b32 v5, 2, v2
    v_add_u32 v5, 162880, v5
    v_cndmask_b32 v16, -1, v16, vcc
    v_mov_b32 v17, -1
    ds_write_b32 v5, v16
    ds_write_b32 v5, v17 offset:256
    s_branch L_h_bar0
L_h_not4:
    s_cmp_lg_u32 s3, 6
    s_cbranch_scc1 L_h_bar0
    s_cmp_lg_u32 s97, 0
    s_cbranch_scc1 L_nocinit
    s_lshl_b32 s6, s4, 3
    s_add_u32 s6, s6, s96
    s_lshl_b32 s6, s6, 8
    s_add_u32 s6, s6, 950272
    s_waitcnt lgkmcnt(0)
    s_lshr_b64 s[18:19], s[16:17], 2
    s_and_b32 s7, s18, 0xffffff00
    v_mov_b32 v16, s7
    v_mov_b32 v17, 0
    s_mov_b64 exec, 1
    buffer_store_dword v16, v17, s[52:55], s6 offen sc1
    s_mov_b64 exec, s[58:59]
L_nocinit:
L_h_bar0:
    s_waitcnt lgkmcnt(0)
    s_barrier
    s_lshr_b64 s[16:17], s[16:17], 10
    s_cmp_eq_u32 s3, 4
    s_cbranch_scc1 L_h_w14
    s_cmp_eq_u32 s3, 6
    s_cbranch_scc1 L_h_w3
    s_waitcnt vmcnt(0)
    s_branch L_h_ln
L_h_w14:
    s_waitcnt vmcnt(14)
    s_branch L_h_ln
L_h_w3:
    s_waitcnt vmcnt(1)
    s_cmp_eq_u32 s97, 0
    s_cbranch_scc1 L_h_ln
    s_waitcnt vmcnt(0)
L_h_ln:
    v_lshlrev_b32 v16, 16, v8
    v_and_b32 v17, 0xffff0000, v8
    v_lshlrev_b32 v18, 16, v9
    v_and_b32 v19, 0xffff0000, v9
    v_lshlrev_b32 v20, 16, v10
    v_and_b32 v21, 0xffff0000, v10
    v_lshlrev_b32 v22, 16, v11
    v_and_b32 v23, 0xffff0000, v11
    v_lshlrev_b32 v24, 16, v12
    v_and_b32 v25, 0xffff0000, v12
    v_lshlrev_b32 v26, 16, v13
    v_and_b32 v27, 0xffff0000, v13
    v_lshlrev_b32 v28, 16, v14
    v_and_b32 v29, 0xffff0000, v14
    v_lshlrev_b32 v30, 16, v15
    v_and_b32 v31, 0xffff0000, v15
    v_add_f32 v32, v16, v17
    v_add_f32 v35, v24, v25
    v_add_f32 v32, v32, v18
    v_add_f32 v35, v35, v26
    v_add_f32 v32, v32, v19
    v_add_f32 v35, v35, v27
    v_add_f32 v32, v32, v20
    v_add_f32 v35, v35, v28
    v_add_f32 v32, v32, v21
    v_add_f32 v35, v35, v29
    v_add_f32 v32, v32, v22
    v_add_f32 v35, v35, v30
    v_add_f32 v32, v32, v23
    v_add_f32 v35, v35, v31
    s_nop 0
    v_add_f32_dpp v32, v32, v32 quad_perm:[1,0,3,2] row_mask:0xf bank_mask:0xf
    v_add_f32_dpp v35, v35, v35 quad_perm:[1,0,3,2] row_mask:0xf bank_mask:0xf
    s_nop 0
    v_add_f32_dpp v32, v32, v32 quad_perm:[2,3,0,1] row_mask:0xf bank_mask:0xf
    v_add_f32_dpp v35, v35, v35 quad_perm:[2,3,0,1] row_mask:0xf bank_mask:0xf
    s_nop 0
    v_add_f32_dpp v32, v32, v32 row_half_mirror row_mask:0xf bank_mask:0xf
    v_add_f32_dpp v35, v35, v35 row_half_mirror row_mask:0xf bank_mask:0xf
    s_nop 0
    v_add_f32_dpp v32, v32, v32 row_mirror row_mask:0xf bank_mask:0xf
    v_add_f32_dpp v35, v35, v35 row_mirror row_mask:0xf bank_mask:0xf
    v_mov_b32 v33, v32
    v_mov_b32 v36, v35
    s_nop 1
    v_permlane16_swap_b32 v32, v33
    v_permlane16_swap_b32 v35, v36
    s_nop 1
    v_add_f32 v32, v32, v33
    v_add_f32 v35, v35, v36
    v_mov_b32 v33, v32
    v_mov_b32 v36, v35
    s_nop 1
    v_permlane32_swap_b32 v32, v33
    v_permlane32_swap_b32 v35, v36
    s_nop 1
    v_add_f32 v32, v32, v33
    v_add_f32 v35, v35, v36
    v_mul_f32 v32, 0x3b124925, v32
    v_mul_f32 v35, 0x3b124925, v35
    v_sub_f32 v34, v16, v32
    v_sub_f32 v37, v24, v35
    v_mul_f32 v33, v34, v34
    v_mul_f32 v36, v37, v37
    v_sub_f32 v34, v17, v32
    v_sub_f32 v37, v25, v35
    v_fmac_f32 v33, v34, v34
    v_fmac_f32 v36, v37, v37
    v_sub_f32 v34, v18, v32
    v_sub_f32 v37, v26, v35
    v_fmac_f32 v33, v34, v34
    v_fmac_f32 v36, v37, v37
    v_sub_f32 v34, v19, v32
    v_sub_f32 v37, v27, v35
    v_fmac_f32 v33, v34, v34
    v_fmac_f32 v36, v37, v37
    v_sub_f32 v34, v20, v32
    v_sub_f32 v37, v28, v35
    v_fmac_f32 v33, v34, v34
    v_fmac_f32 v36, v37, v37
    v_sub_f32 v34, v21, v32
    v_sub_f32 v37, v29, v35
    v_fmac_f32 v33, v34, v34
    v_fmac_f32 v36, v37, v37
    v_sub_f32 v34, v22, v32
    v_sub_f32 v37, v30, v35
    v_fmac_f32 v33, v34, v34
    v_fmac_f32 v36, v37, v37
    v_sub_f32 v34, v23, v32
    v_sub_f32 v37, v31, v35
    v_fmac_f32 v33, v34, v34
    v_fmac_f32 v36, v37, v37
    v_cndmask_b32 v33, 0, v33, s[56:57]
    v_cndmask_b32 v36, 0, v36, s[56:57]
    s_nop 0
    v_add_f32_dpp v33, v33, v33 quad_perm:[1,0,3,2] row_mask:0xf bank_mask:0xf
    v_add_f32_dpp v36, v36, v36 quad_perm:[1,0,3,2] row_mask:0xf bank_mask:0xf
    s_nop 0
    v_add_f32_dpp v33, v33, v33 quad_perm:[2,3,0,1] row_mask:0xf bank_mask:0xf
    v_add_f32_dpp v36, v36, v36 quad_perm:[2,3,0,1] row_mask:0xf bank_mask:0xf
    s_nop 0
    v_add_f32_dpp v33, v33, v33 row_half_mirror row_mask:0xf bank_mask:0xf
    v_add_f32_dpp v36, v36, v36 row_half_mirror row_mask:0xf bank_mask:0xf
    s_nop 0
    v_add_f32_dpp v33, v33, v33 row_mirror row_mask:0xf bank_mask:0xf
    v_add_f32_dpp v36, v36, v36 row_mirror row_mask:0xf bank_mask:0xf
    v_mov_b32 v34, v33
    v_mov_b32 v37, v36
    s_nop 1
    v_permlane16_swap_b32 v33, v34
    v_permlane16_swap_b32 v36, v37
    s_nop 1
    v_add_f32 v33, v33, v34
    v_add_f32 v36, v36, v37
    v_mov_b32 v34, v33
    v_mov_b32 v37, v36
    s_nop 1
    v_permlane32_swap_b32 v33, v34
    v_permlane32_swap_b32 v36, v37
    s_nop 1
    v_add_f32 v33, v33, v34
    v_add_f32 v36, v36, v37
    v_mul_f32 v33, 0x3b124925, v33
    v_mul_f32 v36, 0x3b124925, v36
    v_cvt_pk_bf16_f32 v34, v33, v36
    v_lshlrev_b32 v33, 16, v34
    v_and_b32 v36, 0xffff0000, v34
    v_add_f32 v33, 0x3727c5ac, v33
    v_add_f32 v36, 0x3727c5ac, v36
    v_cvt_pk_bf16_f32 v34, v33, v36
    v_lshlrev_b32 v33, 16, v34
    v_and_b32 v36, 0xffff0000, v34
    v_sqrt_f32 v33, v33
    v_sqrt_f32 v36, v36
    s_nop 0
    v_cvt_pk_bf16_f32 v34, v33, v36
    v_lshlrev_b32 v33, 16, v34
    v_and_b32 v36, 0xffff0000, v34
    v_rcp_f32 v33, v33
    v_rcp_f32 v36, v36
    v_cvt_pk_bf16_f32 v34, v32, v35
    v_lshlrev_b32 v32, 16, v34
    v_and_b32 v35, 0xffff0000, v34
    v_sub_f32 v16, v16, v32
    v_sub_f32 v17, v17, v32
    v_cvt_pk_bf16_f32 v34, v16, v17
    v_lshlrev_b32 v16, 16, v34
    v_and_b32 v17, 0xffff0000, v34
    v_mul_f32 v16, v16, v33
    v_mul_f32 v17, v17, v33
    v_sub_f32 v18, v18, v32
    v_sub_f32 v19, v19, v32
    v_cvt_pk_bf16_f32 v34, v18, v19
    v_lshlrev_b32 v18, 16, v34
    v_and_b32 v19, 0xffff0000, v34
    v_mul_f32 v18, v18, v33
    v_mul_f32 v19, v19, v33
    v_sub_f32 v20, v20, v32
    v_sub_f32 v21, v21, v32
    v_cvt_pk_bf16_f32 v34, v20, v21
    v_lshlrev_b32 v20, 16, v34
    v_and_b32 v21, 0xffff0000, v34
    v_mul_f32 v20, v20, v33
    v_mul_f32 v21, v21, v33
    v_sub_f32 v22, v22, v32
    v_sub_f32 v23, v23, v32
    v_cvt_pk_bf16_f32 v34, v22, v23
    v_lshlrev_b32 v22, 16, v34
    v_and_b32 v23, 0xffff0000, v34
    v_mul_f32 v22, v22, v33
    v_mul_f32 v23, v23, v33
    v_sub_f32 v24, v24, v35
    v_sub_f32 v25, v25, v35
    v_cvt_pk_bf16_f32 v34, v24, v25
    v_lshlrev_b32 v24, 16, v34
    v_and_b32 v25, 0xffff0000, v34
    v_mul_f32 v24, v24, v36
    v_mul_f32 v25, v25, v36
    v_sub_f32 v26, v26, v35
    v_sub_f32 v27, v27, v35
    v_cvt_pk_bf16_f32 v34, v26, v27
    v_lshlrev_b32 v26, 16, v34
    v_and_b32 v27, 0xffff0000, v34
    v_mul_f32 v26, v26, v36
    v_mul_f32 v27, v27, v36
    v_sub_f32 v28, v28, v35
    v_sub_f32 v29, v29, v35
    v_cvt_pk_bf16_f32 v34, v28, v29
    v_lshlrev_b32 v28, 16, v34
    v_and_b32 v29, 0xffff0000, v34
    v_mul_f32 v28, v28, v36
    v_mul_f32 v29, v29, v36
    v_sub_f32 v30, v30, v35
    v_sub_f32 v31, v31, v35
    v_cvt_pk_bf16_f32 v34, v30, v31
    v_lshlrev_b32 v30, 16, v34
    v_and_b32 v31, 0xffff0000, v34
    v_mul_f32 v30, v30, v36
    v_mul_f32 v31, v31, v36
    v_cvt_pk_bf16_f32 v8, v16, v17
    v_cvt_pk_bf16_f32 v9, v18, v19
    v_cvt_pk_bf16_f32 v10, v20, v21
    v_cvt_pk_bf16_f32 v11, v22, v23
    v_cvt_pk_bf16_f32 v12, v24, v25
    v_cvt_pk_bf16_f32 v13, v26, v27
    v_cvt_pk_bf16_f32 v14, v28, v29
    v_cvt_pk_bf16_f32 v15, v30, v31
    v_lshlrev_b32 v5, 4, v2
    s_add_u32 s6, s15, 145408
    v_add_u32 v5, s6, v5
    s_mov_b64 exec, s[56:57]
    ds_write_b128 v5, v[8:11]
    ds_write_b128 v5, v[12:15] offset:896
    s_mov_b64 exec, 1
    v_mov_b32 v5, 162816
    v_mov_b32 v6, 1
    s_waitcnt lgkmcnt(0)
    ds_add_u32 v5, v6
    s_mov_b64 exec, s[58:59]
    s_lshl_b32 s7, s4, 5
    v_mov_b32 v9, s7
    v_mov_b32 v8, 1
    s_cmp_eq_u32 s3, 4
    s_cbranch_scc1 L_service
    s_cmp_eq_u32 s3, 5
    s_cbranch_scc1 L_w5
    s_cmp_lg_u32 s3, 6
    s_cbranch_scc1 L_h_bar3
    v_mov_b32 v16, -1
    v_mov_b32 v17, -1
    v_mov_b32 v18, -1
    v_mov_b32 v19, -1
    v_lshlrev_b32 v6, 4, v2
    s_lshl_b32 s6, s98, 11
    s_add_u32 s6, s6, 131072
    buffer_store_dwordx4 v[16:19], v6, s[52:55], s6 offen sc1
    buffer_store_dwordx4 v[16:19], v6, s[52:55], s6 offen offset:1024 sc1
    s_lshl_b32 s6, s98, 8
    s_add_u32 s6, s6, 655360
    s_mov_b64 exec, 0xffff
    buffer_store_dwordx4 v[16:19], v6, s[52:55], s6 offen sc1
    s_mov_b64 exec, s[58:59]
    s_cmp_ge_u32 s38, 28
    s_cbranch_scc1 L_clr_done
    s_lshl_b32 s6, s4, 1
    s_mul_i32 s6, s6, 14
    s_add_u32 s6, s6, s38
    s_lshl_b32 s6, s6, 10
    s_add_u32 s6, s6, 720896
    buffer_store_dwordx4 v[16:19], v6, s[52:55], s6 offen sc1
L_clr_done:
    s_mov_b64 exec, 1
    s_waitcnt vmcnt(0)
    buffer_atomic_add v8, v9, s[72:75], 0 offen sc1
    s_mov_b64 exec, s[58:59]
    s_branch L_h_bar3
L_w5:
    v_mov_b32 v5, 162828
    s_mov_b32 s13, 0
L_w5s:
    s_sleep 32
    ds_read_b32 v6, v5
    s_add_u32 s13, s13, 1
    s_waitcnt lgkmcnt(0)
    v_readfirstlane_b32 s6, v6
    s_cmp_ge_u32 s13, 0x10000
    s_cbranch_scc1 L_w5s_d
    s_cmp_lt_u32 s6, 20
    s_cbranch_scc1 L_w5s
L_w5s_d:
    v_lshlrev_b32 v9, 5, v2
    v_cmp_gt_u32 vcc, 8, v2
    s_mov_b32 s13, 0
    s_and_b64 exec, exec, vcc
L_pollall:
    buffer_load_dword v10, v9, s[72:75], 0 offen sc1
    s_add_u32 s13, s13, 1
    s_waitcnt vmcnt(0)
    v_cmp_gt_u32 vcc, 64, v10
    s_cmp_ge_u32 s13, 262144
    s_cbranch_scc1 L_pollall_done
    s_cbranch_vccz L_pollall_done
    s_sleep 64
    s_branch L_pollall
L_pollall_done:
    s_mov_b64 exec, s[58:59]
L_h_bar3:
    s_barrier
    s_branch L_tail
L_service:
    v_bfe_u32 v6, v2, 2, 2
    v_lshl_add_u32 v6, v4, 3, v6
    v_lshlrev_b32 v6, 5, v6
    v_and_b32 v7, 3, v2
    v_lshl_add_u32 v6, v7, 3, v6
    v_add_u32 v10, 131072, v6
    v_and_b32 v7, 7, v2
    v_mul_u32_u24 v7, 896, v7
    v_lshl_add_u32 v7, v4, 4, v7
    v_add_u32 v7, 145408, v7
    s_waitcnt vmcnt(0)
    ds_read_b64_tr_b16 v[40:41], v10 offset:0
    ds_read_b64_tr_b16 v[42:43], v10 offset:128
    ds_read_b64_tr_b16 v[44:45], v10 offset:1024
    ds_read_b64_tr_b16 v[46:47], v10 offset:1152
    ds_read_b64_tr_b16 v[48:49], v10 offset:2048
    ds_read_b64_tr_b16 v[50:51], v10 offset:2176
    ds_read_b64_tr_b16 v[52:53], v10 offset:3072
    ds_read_b64_tr_b16 v[54:55], v10 offset:3200
    ds_read_b64_tr_b16 v[56:57], v10 offset:4096
    ds_read_b64_tr_b16 v[58:59], v10 offset:4224
    ds_read_b64_tr_b16 v[60:61], v10 offset:5120
    ds_read_b64_tr_b16 v[62:63], v10 offset:5248
    ds_read_b64_tr_b16 v[64:65], v10 offset:6144
    ds_read_b64_tr_b16 v[66:67], v10 offset:6272
    ds_read_b64_tr_b16 v[68:69], v10 offset:7168
    ds_read_b64_tr_b16 v[70:71], v10 offset:7296
    ds_read_b64_tr_b16 v[72:73], v10 offset:8192
    ds_read_b64_tr_b16 v[74:75], v10 offset:8320
    ds_read_b64_tr_b16 v[76:77], v10 offset:9216
    ds_read_b64_tr_b16 v[78:79], v10 offset:9344
    ds_read_b64_tr_b16 v[80:81], v10 offset:10240
    ds_read_b64_tr_b16 v[82:83], v10 offset:10368
    ds_read_b64_tr_b16 v[84:85], v10 offset:11264
    ds_read_b64_tr_b16 v[86:87], v10 offset:11392
    ds_read_b64_tr_b16 v[88:89], v10 offset:12288
    ds_read_b64_tr_b16 v[90:91], v10 offset:12416
    ds_read_b64_tr_b16 v[92:93], v10 offset:13312
    ds_read_b64_tr_b16 v[94:95], v10 offset:13440
    v_mov_b32 v5, 162816
L_spin0:
    ds_read_b32 v6, v5
    s_waitcnt lgkmcnt(0)
    v_readfirstlane_b32 s6, v6
    s_cmp_ge_u32 s6, 4
    s_cbranch_scc1 L_spin0_d
    s_sleep 1
    s_branch L_spin0
L_spin0_d:
    ds_read_b128 v[100:103], v7 offset:0
    ds_read_b128 v[104:107], v7 offset:64
    ds_read_b128 v[108:111], v7 offset:128
    ds_read_b128 v[112:115], v7 offset:192
    ds_read_b128 v[116:119], v7 offset:256
    ds_read_b128 v[120:123], v7 offset:320
    ds_read_b128 v[124:127], v7 offset:384
    ds_read_b128 v[128:131], v7 offset:448
    ds_read_b128 v[132:135], v7 offset:512
    ds_read_b128 v[136:139], v7 offset:576
    ds_read_b128 v[140:143], v7 offset:640
    ds_read_b128 v[144:147], v7 offset:704
    ds_read_b128 v[148:151], v7 offset:768
    ds_read_b128 v[152:155], v7 offset:832
    s_waitcnt lgkmcnt(13)
    v_mfma_f32_16x16x32_bf16 v[32:35], v[40:43], v[100:103], 0
    s_waitcnt lgkmcnt(12)
    v_mfma_f32_16x16x32_bf16 v[32:35], v[44:47], v[104:107], v[32:35]
    s_waitcnt lgkmcnt(11)
    v_mfma_f32_16x16x32_bf16 v[32:35], v[48:51], v[108:111], v[32:35]
    s_waitcnt lgkmcnt(10)
    v_mfma_f32_16x16x32_bf16 v[32:35], v[52:55], v[112:115], v[32:35]
    s_waitcnt lgkmcnt(9)
    v_mfma_f32_16x16x32_bf16 v[32:35], v[56:59], v[116:119], v[32:35]
    s_waitcnt lgkmcnt(8)
    v_mfma_f32_16x16x32_bf16 v[32:35], v[60:63], v[120:123], v[32:35]
    s_waitcnt lgkmcnt(7)
    v_mfma_f32_16x16x32_bf16 v[32:35], v[64:67], v[124:127], v[32:35]
    s_waitcnt lgkmcnt(6)
    v_mfma_f32_16x16x32_bf16 v[32:35], v[68:71], v[128:131], v[32:35]
    s_waitcnt lgkmcnt(5)
    v_mfma_f32_16x16x32_bf16 v[32:35], v[72:75], v[132:135], v[32:35]
    s_waitcnt lgkmcnt(4)
    v_mfma_f32_16x16x32_bf16 v[32:35], v[76:79], v[136:139], v[32:35]
    s_waitcnt lgkmcnt(3)
    v_mfma_f32_16x16x32_bf16 v[32:35], v[80:83], v[140:143], v[32:35]
    s_waitcnt lgkmcnt(2)
    v_mfma_f32_16x16x32_bf16 v[32:35], v[84:87], v[144:147], v[32:35]
    s_waitcnt lgkmcnt(1)
    v_mfma_f32_16x16x32_bf16 v[32:35], v[88:91], v[148:151], v[32:35]
    s_waitcnt lgkmcnt(0)
    v_mfma_f32_16x16x32_bf16 v[32:35], v[92:95], v[152:155], v[32:35]
    v_cmp_gt_u32 vcc, 8, v3
    v_lshlrev_b32 v5, 6, v3
    v_lshl_add_u32 v5, v4, 4, v5
    s_lshl_b32 s6, s39, 9
    v_mov_b32 v37, s16
    v_mov_b32 v39, s16
    v_mov_b32 v6, 162820
    s_sub_u32 s17, s16, 2
    s_nop 1
    v_cvt_pk_bf16_f32 v36, v32, v33
    v_cvt_pk_bf16_f32 v38, v34, v35
    s_and_b64 exec, exec, vcc
    buffer_store_dwordx4 v[36:39], v5, s[52:55], s6 offen offset:0 sc1
    s_mov_b64 exec, 1
    ds_write_b32 v6, v8
    s_mov_b64 exec, s[58:59]
    v_lshrrev_b32 v5, 1, v2
    v_lshlrev_b32 v5, 9, v5
    v_and_b32 v6, 1, v2
    v_lshl_add_u32 v5, v6, 5, v5
    s_lshl_b32 s6, s96, 6
    s_lshl_b32 s7, s4, 14
    s_add_u32 s15, s6, s7
    s_mov_b32 s13, 0
    buffer_load_dwordx4 v[12:15], v5, s[52:55], s15 offen offset:0 sc1
    buffer_load_dwordx4 v[16:19], v5, s[52:55], s15 offen offset:16 sc1
L_pq2:
    buffer_load_dwordx4 v[24:27], v5, s[52:55], s15 offen offset:0 sc1
    buffer_load_dwordx4 v[28:31], v5, s[52:55], s15 offen offset:16 sc1
    s_waitcnt vmcnt(2)
    v_subrev_u32 v20, s17, v13
    v_subrev_u32 v21, s17, v15
    v_subrev_u32 v22, s17, v17
    v_subrev_u32 v23, s17, v19
    v_max_u32 v20, v20, v21
    v_max3_u32 v20, v20, v22, v23
    v_cmp_lt_u32 vcc, 4, v20
    s_cbranch_vccz L_pollq_done
    buffer_load_dwordx4 v[12:15], v5, s[52:55], s15 offen offset:0 sc1
    buffer_load_dwordx4 v[16:19], v5, s[52:55], s15 offen offset:16 sc1
    s_waitcnt vmcnt(2)
    v_subrev_u32 v20, s17, v25
    v_subrev_u32 v21, s17, v27
    v_subrev_u32 v22, s17, v29
    v_subrev_u32 v23, s17, v31
    v_max_u32 v20, v20, v21
    v_max3_u32 v20, v20, v22, v23
    v_cmp_lt_u32 vcc, 4, v20
    s_cbranch_vccz L_pq_useB
    s_add_u32 s13, s13, 2
    s_cmp_lt_u32 s13, 2047
    s_cbranch_scc1 L_pq2
    s_mov_b32 s13, 2047
    s_branch L_pollq
L_pq_useB:
    v_mov_b32 v32, v24
    v_mov_b32 v33, v26
    v_mov_b32 v34, v28
    v_mov_b32 v35, v30
    s_branch L_pollq_wr
L_pollq:
    buffer_load_dwordx4 v[12:15], v5, s[52:55], s15 offen offset:0 sc1
    buffer_load_dwordx4 v[16:19], v5, s[52:55], s15 offen offset:16 sc1
    s_waitcnt vmcnt(0)
    s_cmp_lg_u32 s13, 2047
    s_cbranch_scc1 L_pq_noat
    s_mov_b64 exec, 1
    buffer_atomic_add v8, v9, s[72:75], 0 offen sc1
    s_mov_b64 exec, s[58:59]
L_pq_noat:
    s_add_u32 s13, s13, 1
    v_subrev_u32 v20, s17, v13
    v_subrev_u32 v21, s17, v15
    v_subrev_u32 v22, s17, v17
    v_subrev_u32 v23, s17, v19
    v_max_u32 v20, v20, v21
    v_max3_u32 v20, v20, v22, v23
    v_cmp_lt_u32 vcc, 4, v20
    s_cbranch_vccz L_pollq_done
    buffer_load_dword v10, v9, s[72:75], 0 offen sc1
    s_waitcnt vmcnt(0)
    v_readfirstlane_b32 s6, v10
    s_cmp_ge_u32 s13, 262144
    s_cbranch_scc1 L_pollq_done
    s_cmp_ge_u32 s6, 64
    s_cbranch_scc0 L_pollq
    buffer_load_dwordx4 v[12:15], v5, s[52:55], s15 offen offset:0 sc1
    buffer_load_dwordx4 v[16:19], v5, s[52:55], s15 offen offset:16 sc1
    s_waitcnt vmcnt(0)
L_pollq_done:
    v_mov_b32 v32, v12
    v_mov_b32 v33, v14
    v_mov_b32 v34, v16
    v_mov_b32 v35, v18
L_pollq_wr:
    v_lshlrev_b32 v5, 4, v2
    v_add_u32 v5, 152576, v5
    v_mov_b32 v6, 162824
    ds_write_b128 v5, v[32:35]
    s_waitcnt lgkmcnt(0)
    s_mov_b64 exec, 1
    ds_write_b32 v6, v8
    s_cmp_ge_u32 s13, 2048
    s_cbranch_scc1 L_pq_noat2
    buffer_atomic_add v8, v9, s[72:75], 0 offen sc1
L_pq_noat2:
    s_mov_b64 exec, s[58:59]
    s_waitcnt vmcnt(1)
    s_cmp_ge_u32 s38, 28
    s_cbranch_scc1 L_nowo
    v_lshrrev_b32 v5, 2, v2
    v_mul_u32_u24 v5, 896, v5
    v_and_b32 v6, 3, v2
    v_lshl_add_u32 v5, v6, 4, v5
    s_mul_i32 s6, s101, 229376
    s_lshl_b32 s7, s100, 6
    s_add_u32 s6, s6, s7
    s_mov_b32 s7, 131072
    s_mov_b32 m0, s7
    s_add_u32 s7, s7, 1024
    buffer_load_dwordx4 v5, s[68:71], s6 offen lds
    s_add_u32 s6, s6, 14336
    s_mov_b32 m0, s7
    s_add_u32 s7, s7, 1024
    buffer_load_dwordx4 v5, s[68:71], s6 offen lds
    s_add_u32 s6, s6, 14336
    s_mov_b32 m0, s7
    s_add_u32 s7, s7, 1024
    buffer_load_dwordx4 v5, s[68:71], s6 offen lds
    s_add_u32 s6, s6, 14336
    s_mov_b32 m0, s7
    s_add_u32 s7, s7, 1024
    buffer_load_dwordx4 v5, s[68:71], s6 offen lds
    s_add_u32 s6, s6, 14336
    s_mov_b32 m0, s7
    s_add_u32 s7, s7, 1024
    buffer_load_dwordx4 v5, s[68:71], s6 offen lds
    s_add_u32 s6, s6, 14336
    s_mov_b32 m0, s7
    s_add_u32 s7, s7, 1024
    buffer_load_dwordx4 v5, s[68:71], s6 offen lds
    s_add_u32 s6, s6, 14336
    s_mov_b32 m0, s7
    s_add_u32 s7, s7, 1024
    buffer_load_dwordx4 v5, s[68:71], s6 offen lds
    s_add_u32 s6, s6, 14336
    s_mov_b32 m0, s7
    s_add_u32 s7, s7, 1024
    buffer_load_dwordx4 v5, s[68:71], s6 offen lds
    s_add_u32 s6, s6, 14336
    s_mov_b32 m0, s7
    s_add_u32 s7, s7, 1024
    buffer_load_dwordx4 v5, s[68:71], s6 offen lds
    s_add_u32 s6, s6, 14336
    s_mov_b32 m0, s7
    s_add_u32 s7, s7, 1024
    buffer_load_dwordx4 v5, s[68:71], s6 offen lds
    s_add_u32 s6, s6, 14336
    s_mov_b32 m0, s7
    s_add_u32 s7, s7, 1024
    buffer_load_dwordx4 v5, s[68:71], s6 offen lds
    s_add_u32 s6, s6, 14336
    s_mov_b32 m0, s7
    s_add_u32 s7, s7, 1024
    buffer_load_dwordx4 v5, s[68:71], s6 offen lds
    s_add_u32 s6, s6, 14336
    s_mov_b32 m0, s7
    s_add_u32 s7, s7, 1024
    buffer_load_dwordx4 v5, s[68:71], s6 offen lds
    s_add_u32 s6, s6, 14336
    s_mov_b32 m0, s7
    s_add_u32 s7, s7, 1024
    buffer_load_dwordx4 v5, s[68:71], s6 offen lds
    s_add_u32 s6, s6, 14336
    s_mov_b32 m0, s7
    s_add_u32 s7, s7, 1024
    buffer_load_dwordx4 v5, s[68:71], s6 offen lds
    s_add_u32 s6, s6, 14336
    s_mov_b32 m0, s7
    s_add_u32 s7, s7, 1024
    buffer_load_dwordx4 v5, s[68:71], s6 offen lds
    s_add_u32 s6, s6, 14336
L_nowo:
    s_lshl_b32 s6, s4, 3
    s_add_u32 s6, s6, s96
    s_lshl_b32 s6, s6, 8
    s_add_u32 s25, s6, 950272
    v_mov_b32 v14, 0
    s_mov_b32 s13, 0
L_pcnt:
    buffer_load_dword v10, v14, s[52:55], s25 offen sc1
    s_add_u32 s13, s13, 1
    s_waitcnt vmcnt(0)
    v_readfirstlane_b32 s6, v10
    s_lshr_b32 s6, s6, 8
    s_sub_u32 s6, s6, s17
    s_and_b32 s6, s6, 0xffffff
    s_cmp_le_u32 s6, 4
    s_cbranch_scc1 L_pcnt_done
    s_sleep 16
    s_cmp_lt_u32 s13, 1024
    s_cbranch_scc1 L_pcnt
    buffer_load_dword v10, v9, s[72:75], 0 offen sc1
    s_waitcnt vmcnt(0)
    v_readfirstlane_b32 s6, v10
    s_cmp_ge_u32 s13, 262144
    s_cbranch_scc1 L_pcnt_done
    s_cmp_ge_u32 s6, 64
    s_cbranch_scc0 L_pcnt
L_pcnt_done:
    s_mov_b32 s22, 1
    s_mov_b32 s23, 24
    s_mov_b32 s24, 24
    v_mov_b32 v11, 162828
    v_mov_b32 v10, s22
    s_waitcnt vmcnt(0)
L_dyn:
    ds_read_b32 v6, v11
    s_waitcnt lgkmcnt(0)
    v_readfirstlane_b32 s6, v6
    s_add_u32 s6, s6, 4
    s_cmp_ge_u32 s6, s23
    s_cbranch_scc1 L_dyn_go
    s_sleep 4
    s_branch L_dyn
L_dyn_go:
    s_sub_u32 s6, s23, 24
    s_lshl_b64 exec, 1, s6
    buffer_atomic_add v10, v14, s[52:55], s25 offen sc0 sc1
    s_mov_b64 exec, s[58:59]
    s_add_u32 s23, s23, 1
    s_sub_u32 s6, s23, s24
    s_cmp_le_u32 s6, 2
    s_cbranch_scc1 L_dyn
    s_waitcnt vmcnt(2)
    s_sub_u32 s6, s24, 24
    v_readlane_b32 s6, v10, s6
    s_and_b32 s6, s6, 0xff
    s_add_u32 s7, s6, 96
    s_cmp_lt_u32 s6, 32
    s_cselect_b32 s7, s7, 0x1000
    s_lshl_b32 s6, s24, 2
    s_add_u32 s6, s6, 162880
    v_mov_b32 v12, s6
    v_mov_b32 v13, s7
    ds_write_b32 v12, v13
    s_add_u32 s24, s24, 1
    s_cmp_lt_u32 s7, 128
    s_cbranch_scc1 L_dyn
    v_add_u32 v12, 4, v12
    ds_write_b32 v12, v13
    s_waitcnt vmcnt(0) lgkmcnt(0)
L_skipdyn:
    s_waitcnt vmcnt(0)
    s_barrier
    s_branch L_tail
L_stream:
    s_mov_b32 s44, s18
    s_and_b32 s45, s19, 0xffff
    s_mov_b32 s46, 268435456
    s_mov_b32 s47, 0x00020000
    s_mov_b32 s48, s20
    s_and_b32 s49, s21, 0xffff
    s_mov_b32 s50, 268435456
    s_mov_b32 s51, 0x00020000
    s_mov_b32 s52, s40
    s_and_b32 s53, s41, 0xffff
    s_mov_b32 s54, 4194304
    s_mov_b32 s55, 0x00020000
    s_mov_b32 s68, s24
    s_and_b32 s69, s25, 0xffff
    s_mov_b32 s70, 3670016
    s_mov_b32 s71, 0x00020000
    s_mov_b32 s76, s36
    s_and_b32 s77, s37, 0xffff
    s_mov_b32 s78, 7168
    s_mov_b32 s79, 0x00020000
    s_mov_b32 s80, s28
    s_and_b32 s81, s29, 0xffff
    s_mov_b32 s82, 3584
    s_mov_b32 s83, 0x00020000
    s_mov_b32 s84, s30
    s_and_b32 s85, s31, 0xffff
    s_mov_b32 s86, 3584
    s_mov_b32 s87, 0x00020000
    s_mov_b32 s88, s32
    s_and_b32 s89, s33, 0xffff
    s_mov_b32 s90, 3584
    s_mov_b32 s91, 0x00020000
    s_mov_b32 s92, s34
    s_and_b32 s93, s35, 0xffff
    s_mov_b32 s94, 4
    s_mov_b32 s95, 0x00020000
    v_lshrrev_b32 v7, 5, v2
    v_and_b32 v8, 31, v2
    v_add_u32 v5, 0, v7
    v_xor_b32 v6, v8, v5
    v_lshlrev_b32 v6, 4, v6
    v_lshl_add_u32 v192, v7, 9, v6
    v_add_u32 v192, 0, v192
    v_and_b32 v5, 7, v5
    v_lshlrev_b32 v5, 1, v5
    v_xor_b32 v6, v8, v5
    v_lshlrev_b32 v6, 4, v6
    v_lshl_add_u32 v200, v7, 9, v6
    v_add_u32 v200, 0, v200
    v_add_u32 v5, 2, v7
    v_xor_b32 v6, v8, v5
    v_lshlrev_b32 v6, 4, v6
    v_lshl_add_u32 v193, v7, 9, v6
    v_add_u32 v193, 3072, v193
    v_and_b32 v5, 7, v5
    v_lshlrev_b32 v5, 1, v5
    v_xor_b32 v6, v8, v5
    v_lshlrev_b32 v6, 4, v6
    v_lshl_add_u32 v201, v7, 9, v6
    v_add_u32 v201, 3072, v201
    v_add_u32 v5, 4, v7
    v_xor_b32 v6, v8, v5
    v_lshlrev_b32 v6, 4, v6
    v_lshl_add_u32 v194, v7, 9, v6
    v_add_u32 v194, 6144, v194
    v_and_b32 v5, 7, v5
    v_lshlrev_b32 v5, 1, v5
    v_xor_b32 v6, v8, v5
    v_lshlrev_b32 v6, 4, v6
    v_lshl_add_u32 v202, v7, 9, v6
    v_add_u32 v202, 6144, v202
    v_add_u32 v5, 6, v7
    v_xor_b32 v6, v8, v5
    v_lshlrev_b32 v6, 4, v6
    v_lshl_add_u32 v195, v7, 9, v6
    v_add_u32 v195, 9216, v195
    v_and_b32 v5, 7, v5
    v_lshlrev_b32 v5, 1, v5
    v_xor_b32 v6, v8, v5
    v_lshlrev_b32 v6, 4, v6
    v_lshl_add_u32 v203, v7, 9, v6
    v_add_u32 v203, 9216, v203
    v_add_u32 v5, 8, v7
    v_xor_b32 v6, v8, v5
    v_lshlrev_b32 v6, 4, v6
    v_lshl_add_u32 v196, v7, 9, v6
    v_add_u32 v196, 16384, v196
    v_and_b32 v5, 7, v5
    v_lshlrev_b32 v5, 1, v5
    v_xor_b32 v6, v8, v5
    v_lshlrev_b32 v6, 4, v6
    v_lshl_add_u32 v204, v7, 9, v6
    v_add_u32 v204, 16384, v204
    v_add_u32 v5, 10, v7
    v_xor_b32 v6, v8, v5
    v_lshlrev_b32 v6, 4, v6
    v_lshl_add_u32 v197, v7, 9, v6
    v_add_u32 v197, 19456, v197
    v_and_b32 v5, 7, v5
    v_lshlrev_b32 v5, 1, v5
    v_xor_b32 v6, v8, v5
    v_lshlrev_b32 v6, 4, v6
    v_lshl_add_u32 v205, v7, 9, v6
    v_add_u32 v205, 19456, v205
    v_add_u32 v5, 12, v7
    v_xor_b32 v6, v8, v5
    v_lshlrev_b32 v6, 4, v6
    v_lshl_add_u32 v198, v7, 9, v6
    v_add_u32 v198, 22528, v198
    v_and_b32 v5, 7, v5
    v_lshlrev_b32 v5, 1, v5
    v_xor_b32 v6, v8, v5
    v_lshlrev_b32 v6, 4, v6
    v_lshl_add_u32 v206, v7, 9, v6
    v_add_u32 v206, 22528, v206
    v_add_u32 v5, 14, v7
    v_xor_b32 v6, v8, v5
    v_lshlrev_b32 v6, 4, v6
    v_lshl_add_u32 v199, v7, 9, v6
    v_add_u32 v199, 25600, v199
    v_and_b32 v5, 7, v5
    v_lshlrev_b32 v5, 1, v5
    v_xor_b32 v6, v8, v5
    v_lshlrev_b32 v6, 4, v6
    v_lshl_add_u32 v207, v7, 9, v6
    v_add_u32 v207, 25600, v207
    s_lshl_b32 s8, s3, 15
    s_lshl_b32 s20, s96, 3
    s_add_u32 s20, s20, s4
    s_lshl_b32 s20, s20, 22
    s_mul_i32 s6, s3, 1024
    s_add_u32 s20, s20, s6
    s_mul_i32 s6, s97, 786432
    s_add_u32 s9, s20, s6
    s_barrier
    s_add_u32 s11, s8, 0
    s_mov_b32 m0, s11
    s_add_u32 s12, s8, 4096
    buffer_load_dwordx4 v192, s[44:47], s9 offen offset:0 nt lds
    buffer_load_dwordx4 v193, s[44:47], s9 offen offset:1024 nt lds
    buffer_load_dwordx4 v194, s[44:47], s9 offen offset:2048 nt lds
    buffer_load_dwordx4 v195, s[44:47], s9 offen offset:3072 nt lds
    s_mov_b32 m0, s12
    s_nop 0
    buffer_load_dwordx4 v196, s[44:47], s9 offen offset:0 nt lds
    buffer_load_dwordx4 v197, s[44:47], s9 offen offset:1024 nt lds
    buffer_load_dwordx4 v198, s[44:47], s9 offen offset:2048 nt lds
    buffer_load_dwordx4 v199, s[44:47], s9 offen offset:3072 nt lds
    s_add_u32 s11, s8, 8192
    s_mov_b32 m0, s11
    s_add_u32 s12, s8, 12288
    buffer_load_dwordx4 v200, s[48:51], s9 offen offset:0 nt lds
    buffer_load_dwordx4 v201, s[48:51], s9 offen offset:1024 nt lds
    buffer_load_dwordx4 v202, s[48:51], s9 offen offset:2048 nt lds
    buffer_load_dwordx4 v203, s[48:51], s9 offen offset:3072 nt lds
    s_mov_b32 m0, s12
    s_nop 0
    buffer_load_dwordx4 v204, s[48:51], s9 offen offset:0 nt lds
    buffer_load_dwordx4 v205, s[48:51], s9 offen offset:1024 nt lds
    buffer_load_dwordx4 v206, s[48:51], s9 offen offset:2048 nt lds
    buffer_load_dwordx4 v207, s[48:51], s9 offen offset:3072 nt lds
    s_add_u32 s9, s9, 32768
    v_add_u32 v5, 0, v4
    v_xor_b32 v5, v5, v3
    v_lshlrev_b32 v5, 4, v5
    v_lshl_add_u32 v5, v3, 9, v5
    v_add_u32 v208, s8, v5
    v_add_u32 v5, 4, v4
    v_xor_b32 v5, v5, v3
    v_lshlrev_b32 v5, 4, v5
    v_lshl_add_u32 v5, v3, 9, v5
    v_add_u32 v209, s8, v5
    v_add_u32 v5, 8, v4
    v_xor_b32 v5, v5, v3
    v_lshlrev_b32 v5, 4, v5
    v_lshl_add_u32 v5, v3, 9, v5
    v_add_u32 v210, s8, v5
    v_add_u32 v5, 12, v4
    v_xor_b32 v5, v5, v3
    v_lshlrev_b32 v5, 4, v5
    v_lshl_add_u32 v5, v3, 9, v5
    v_add_u32 v211, s8, v5
    v_bfe_u32 v5, v2, 2, 2
    v_lshl_add_u32 v5, v4, 2, v5
    v_and_b32 v6, 7, v5
    v_and_b32 v7, 3, v2
    v_lshlrev_b32 v7, 3, v7
    v_lshl_add_u32 v7, v5, 9, v7
    v_add_u32 v7, s8, v7
    v_xor_b32 v5, 0, v6
    v_lshl_add_u32 v212, v5, 5, v7
    v_xor_b32 v5, 1, v6
    v_lshl_add_u32 v213, v5, 5, v7
    v_xor_b32 v5, 2, v6
    v_lshl_add_u32 v214, v5, 5, v7
    v_xor_b32 v5, 3, v6
    v_lshl_add_u32 v215, v5, 5, v7
    v_xor_b32 v5, 4, v6
    v_lshl_add_u32 v216, v5, 5, v7
    v_xor_b32 v5, 5, v6
    v_lshl_add_u32 v217, v5, 5, v7
    v_xor_b32 v5, 6, v6
    v_lshl_add_u32 v218, v5, 5, v7
    v_xor_b32 v5, 7, v6
    v_lshl_add_u32 v219, v5, 5, v7
    v_mov_b32 v64, 0
    v_mov_b32 v65, 0
    v_mov_b32 v66, 0
    v_mov_b32 v67, 0
    v_mov_b32 v68, 0
    v_mov_b32 v69, 0
    v_mov_b32 v70, 0
    v_mov_b32 v71, 0
    v_mov_b32 v72, 0
    v_mov_b32 v73, 0
    v_mov_b32 v74, 0
    v_mov_b32 v75, 0
    v_mov_b32 v76, 0
    v_mov_b32 v77, 0
    v_mov_b32 v78, 0
    v_mov_b32 v79, 0
    v_mov_b32 v80, 0
    v_mov_b32 v81, 0
    v_mov_b32 v82, 0
    v_mov_b32 v83, 0
    v_mov_b32 v84, 0
    v_mov_b32 v85, 0
    v_mov_b32 v86, 0
    v_mov_b32 v87, 0
    v_mov_b32 v88, 0
    v_mov_b32 v89, 0
    v_mov_b32 v90, 0
    v_mov_b32 v91, 0
    v_mov_b32 v92, 0
    v_mov_b32 v93, 0
    v_mov_b32 v94, 0
    v_mov_b32 v95, 0
    v_mov_b32 v96, 0
    v_mov_b32 v97, 0
    v_mov_b32 v98, 0
    v_mov_b32 v99, 0
    v_mov_b32 v100, 0
    v_mov_b32 v101, 0
    v_mov_b32 v102, 0
    v_mov_b32 v103, 0
    v_mov_b32 v104, 0
    v_mov_b32 v105, 0
    v_mov_b32 v106, 0
    v_mov_b32 v107, 0
    v_mov_b32 v108, 0
    v_mov_b32 v109, 0
    v_mov_b32 v110, 0
    v_mov_b32 v111, 0
    v_mov_b32 v112, 0
    v_mov_b32 v113, 0
    v_mov_b32 v114, 0
    v_mov_b32 v115, 0
    v_mov_b32 v116, 0
    v_mov_b32 v117, 0
    v_mov_b32 v118, 0
    v_mov_b32 v119, 0
    v_mov_b32 v120, 0
    v_mov_b32 v121, 0
    v_mov_b32 v122, 0
    v_mov_b32 v123, 0
    v_mov_b32 v124, 0
    v_mov_b32 v125, 0
    v_mov_b32 v126, 0
    v_mov_b32 v127, 0
    v_mov_b32 v226, 0xf149f2ca
    v_mov_b32 v227, 0
    s_mov_b32 s14, 0x3db8aa3b
    v_mov_b32 v5, 162820
L_spin1:
    ds_read_b32 v6, v5
    s_waitcnt lgkmcnt(0)
    v_readfirstlane_b32 s6, v6
    s_cmp_ge_u32 s6, 1
    s_cbranch_scc1 L_spin1_d
    s_sleep 1
    s_branch L_spin1
L_spin1_d:
    s_add_u32 s11, s8, 16384
    s_mov_b32 m0, s11
    s_add_u32 s12, s8, 20480
    buffer_load_dwordx4 v192, s[44:47], s9 offen offset:0 nt lds
    buffer_load_dwordx4 v193, s[44:47], s9 offen offset:1024 nt lds
    buffer_load_dwordx4 v194, s[44:47], s9 offen offset:2048 nt lds
    buffer_load_dwordx4 v195, s[44:47], s9 offen offset:3072 nt lds
    s_mov_b32 m0, s12
    s_nop 0
    buffer_load_dwordx4 v196, s[44:47], s9 offen offset:0 nt lds
    buffer_load_dwordx4 v197, s[44:47], s9 offen offset:1024 nt lds
    buffer_load_dwordx4 v198, s[44:47], s9 offen offset:2048 nt lds
    buffer_load_dwordx4 v199, s[44:47], s9 offen offset:3072 nt lds
    s_add_u32 s11, s8, 24576
    s_mov_b32 m0, s11
    s_add_u32 s12, s8, 28672
    buffer_load_dwordx4 v200, s[48:51], s9 offen offset:0 nt lds
    buffer_load_dwordx4 v201, s[48:51], s9 offen offset:1024 nt lds
    buffer_load_dwordx4 v202, s[48:51], s9 offen offset:2048 nt lds
    buffer_load_dwordx4 v203, s[48:51], s9 offen offset:3072 nt lds
    s_mov_b32 m0, s12
    s_nop 0
    buffer_load_dwordx4 v204, s[48:51], s9 offen offset:0 nt lds
    buffer_load_dwordx4 v205, s[48:51], s9 offen offset:1024 nt lds
    buffer_load_dwordx4 v206, s[48:51], s9 offen offset:2048 nt lds
    buffer_load_dwordx4 v207, s[48:51], s9 offen offset:3072 nt lds
    v_mov_b32 v5, 162824
L_spin2:
    ds_read_b32 v6, v5
    s_waitcnt lgkmcnt(0)
    v_readfirstlane_b32 s6, v6
    s_cmp_ge_u32 s6, 1
    s_cbranch_scc1 L_spin2_d
    s_sleep 1
    s_branch L_spin2
L_spin2_d:
    v_and_b32 v5, 1, v2
    v_lshlrev_b32 v5, 9, v5
    v_lshl_add_u32 v5, v4, 4, v5
    v_add_u32 v5, 152576, v5
    ds_read_b128 v[16:19], v5 offset:0
    ds_read_b128 v[20:23], v5 offset:64
    ds_read_b128 v[24:27], v5 offset:128
    ds_read_b128 v[28:31], v5 offset:192
    ds_read_b128 v[32:35], v5 offset:256
    ds_read_b128 v[36:39], v5 offset:320
    ds_read_b128 v[40:43], v5 offset:384
    ds_read_b128 v[44:47], v5 offset:448
    s_waitcnt lgkmcnt(0)
    v_mov_b32 v235, 162888
    v_mov_b32 v238, 162828
    s_mov_b32 s13, 0
    s_mov_b32 s15, 1000
L_loop:
    s_cmp_eq_u32 s15, 1000
    s_cbranch_scc1 L_wk_a
    s_waitcnt vmcnt(0)
L_wk_a:
    s_waitcnt vmcnt(24)
    v_mov_b32 v237, s13
    ds_read_b32 v236, v235
    ds_write_b32 v238, v237
    ds_read_b128 v[128:131], v208 offset:0
    ds_read_b128 v[132:135], v209 offset:0
    ds_read_b128 v[136:139], v210 offset:0
    ds_read_b128 v[140:143], v211 offset:0
    ds_read_b128 v[144:147], v208 offset:256
    ds_read_b128 v[148:151], v209 offset:256
    ds_read_b128 v[152:155], v210 offset:256
    ds_read_b128 v[156:159], v211 offset:256
    s_waitcnt lgkmcnt(7)
    v_mfma_f32_16x16x32_bf16 v[220:223], v[128:131], v[16:19], 0
    s_waitcnt lgkmcnt(6)
    v_mfma_f32_16x16x32_bf16 v[220:223], v[132:135], v[20:23], v[220:223]
    s_waitcnt lgkmcnt(5)
    v_mfma_f32_16x16x32_bf16 v[220:223], v[136:139], v[24:27], v[220:223]
    s_waitcnt lgkmcnt(4)
    v_mfma_f32_16x16x32_bf16 v[220:223], v[140:143], v[28:31], v[220:223]
    s_waitcnt lgkmcnt(3)
    v_mfma_f32_16x16x32_bf16 v[220:223], v[144:147], v[32:35], v[220:223]
    s_waitcnt lgkmcnt(2)
    v_mfma_f32_16x16x32_bf16 v[220:223], v[148:151], v[36:39], v[220:223]
    s_waitcnt lgkmcnt(1)
    v_mfma_f32_16x16x32_bf16 v[220:223], v[152:155], v[40:43], v[220:223]
    s_waitcnt lgkmcnt(0)
    v_mfma_f32_16x16x32_bf16 v[220:223], v[156:159], v[44:47], v[220:223]
    v_readfirstlane_b32 s6, v236
    s_cmp_lg_u32 s6, -1
    s_cbranch_scc1 L_nx_a
L_nxs_a:
    s_sleep 1
    ds_read_b32 v236, v235
    s_waitcnt lgkmcnt(0)
    v_readfirstlane_b32 s6, v236
    s_cmp_eq_u32 s6, -1
    s_cbranch_scc1 L_nxs_a
L_nx_a:
    v_add_u32 v235, 4, v235
    s_lshl_b32 s7, s6, 15
    s_add_u32 s9, s20, s7
    s_add_u32 s7, s13, 2
    s_min_u32 s7, s7, s15
    s_cmp_ge_u32 s6, 128
    s_cselect_b32 s15, s7, s15
    s_cbranch_scc1 L_noik_a
    s_add_u32 s11, s8, 0
    s_mov_b32 m0, s11
    s_add_u32 s12, s8, 4096
    buffer_load_dwordx4 v192, s[44:47], s9 offen offset:0 nt lds
    buffer_load_dwordx4 v193, s[44:47], s9 offen offset:1024 nt lds
    buffer_load_dwordx4 v194, s[44:47], s9 offen offset:2048 nt lds
    buffer_load_dwordx4 v195, s[44:47], s9 offen offset:3072 nt lds
    s_mov_b32 m0, s12
    s_nop 0
    buffer_load_dwordx4 v196, s[44:47], s9 offen offset:0 nt lds
    buffer_load_dwordx4 v197, s[44:47], s9 offen offset:1024 nt lds
    buffer_load_dwordx4 v198, s[44:47], s9 offen offset:2048 nt lds
    buffer_load_dwordx4 v199, s[44:47], s9 offen offset:3072 nt lds
L_noik_a:
    s_nop 3
    v_cvt_pk_bf16_f32 v229, v220, v221
    v_cvt_pk_bf16_f32 v230, v222, v223
    v_lshlrev_b32 v220, 16, v229
    v_and_b32 v221, 0xffff0000, v229
    v_lshlrev_b32 v222, 16, v230
    v_and_b32 v223, 0xffff0000, v230
    v_max3_f32 v229, v220, v221, v222
    v_max_f32 v229, v229, v223
    v_mov_b32 v230, v229
    s_nop 1
    v_permlane16_swap_b32 v229, v230
    s_nop 1
    v_max_f32 v229, v229, v230
    v_mov_b32 v230, v229
    s_nop 1
    v_permlane32_swap_b32 v229, v230
    s_nop 1
    v_max_f32 v229, v229, v230
    v_mul_f32 v229, s14, v229
    v_max_f32 v229, v229, v226
    v_sub_f32 v228, v226, v229
    v_exp_f32 v228, v228
    v_mov_b32 v226, v229
    v_fma_f32 v220, v220, s14, -v229
    v_fma_f32 v221, v221, s14, -v229
    v_fma_f32 v222, v222, s14, -v229
    v_fma_f32 v223, v223, s14, -v229
    v_exp_f32 v220, v220
    v_exp_f32 v221, v221
    v_exp_f32 v222, v222
    v_exp_f32 v223, v223
    v_cmp_neq_f32 vcc, 1.0, v228
    v_cvt_pk_bf16_f32 v224, v220, v221
    v_cvt_pk_bf16_f32 v225, v222, v223
    v_add_f32 v230, v220, v221
    v_add_f32 v231, v222, v223
    v_add_f32 v230, v230, v231
    v_fma_f32 v227, v227, v228, v230
    s_cbranch_vccz L_nors_a
    v_mul_f32 v64, v64, v228
    v_mul_f32 v65, v65, v228
    v_mul_f32 v66, v66, v228
    v_mul_f32 v67, v67, v228
    v_mul_f32 v68, v68, v228
    v_mul_f32 v69, v69, v228
    v_mul_f32 v70, v70, v228
    v_mul_f32 v71, v71, v228
    v_mul_f32 v72, v72, v228
    v_mul_f32 v73, v73, v228
    v_mul_f32 v74, v74, v228
    v_mul_f32 v75, v75, v228
    v_mul_f32 v76, v76, v228
    v_mul_f32 v77, v77, v228
    v_mul_f32 v78, v78, v228
    v_mul_f32 v79, v79, v228
    v_mul_f32 v80, v80, v228
    v_mul_f32 v81, v81, v228
    v_mul_f32 v82, v82, v228
    v_mul_f32 v83, v83, v228
    v_mul_f32 v84, v84, v228
    v_mul_f32 v85, v85, v228
    v_mul_f32 v86, v86, v228
    v_mul_f32 v87, v87, v228
    v_mul_f32 v88, v88, v228
    v_mul_f32 v89, v89, v228
    v_mul_f32 v90, v90, v228
    v_mul_f32 v91, v91, v228
    v_mul_f32 v92, v92, v228
    v_mul_f32 v93, v93, v228
    v_mul_f32 v94, v94, v228
    v_mul_f32 v95, v95, v228
    v_mul_f32 v96, v96, v228
    v_mul_f32 v97, v97, v228
    v_mul_f32 v98, v98, v228
    v_mul_f32 v99, v99, v228
    v_mul_f32 v100, v100, v228
    v_mul_f32 v101, v101, v228
    v_mul_f32 v102, v102, v228
    v_mul_f32 v103, v103, v228
    v_mul_f32 v104, v104, v228
    v_mul_f32 v105, v105, v228
    v_mul_f32 v106, v106, v228
    v_mul_f32 v107, v107, v228
    v_mul_f32 v108, v108, v228
    v_mul_f32 v109, v109, v228
    v_mul_f32 v110, v110, v228
    v_mul_f32 v111, v111, v228
    v_mul_f32 v112, v112, v228
    v_mul_f32 v113, v113, v228
    v_mul_f32 v114, v114, v228
    v_mul_f32 v115, v115, v228
    v_mul_f32 v116, v116, v228
    v_mul_f32 v117, v117, v228
    v_mul_f32 v118, v118, v228
    v_mul_f32 v119, v119, v228
    v_mul_f32 v120, v120, v228
    v_mul_f32 v121, v121, v228
    v_mul_f32 v122, v122, v228
    v_mul_f32 v123, v123, v228
    v_mul_f32 v124, v124, v228
    v_mul_f32 v125, v125, v228
    v_mul_f32 v126, v126, v228
    v_mul_f32 v127, v127, v228
L_nors_a:
    s_cmp_eq_u32 s15, 1000
    s_cbranch_scc1 L_wv_a
    s_waitcnt vmcnt(0)
L_wv_a:
    s_waitcnt vmcnt(24)
    ds_read_b64_tr_b16 v[160:161], v212 offset:8192
    ds_read_b64_tr_b16 v[162:163], v213 offset:8192
    ds_read_b64_tr_b16 v[164:165], v214 offset:8192
    ds_read_b64_tr_b16 v[166:167], v215 offset:8192
    ds_read_b64_tr_b16 v[168:169], v216 offset:8192
    ds_read_b64_tr_b16 v[170:171], v217 offset:8192
    ds_read_b64_tr_b16 v[172:173], v218 offset:8192
    ds_read_b64_tr_b16 v[174:175], v219 offset:8192
    ds_read_b64_tr_b16 v[176:177], v212 offset:8448
    ds_read_b64_tr_b16 v[178:179], v213 offset:8448
    ds_read_b64_tr_b16 v[180:181], v214 offset:8448
    ds_read_b64_tr_b16 v[182:183], v215 offset:8448
    ds_read_b64_tr_b16 v[184:185], v216 offset:8448
    ds_read_b64_tr_b16 v[186:187], v217 offset:8448
    ds_read_b64_tr_b16 v[188:189], v218 offset:8448
    ds_read_b64_tr_b16 v[190:191], v219 offset:8448
    s_waitcnt lgkmcnt(15)
    v_mfma_f32_16x16x16_bf16 v[64:67], v[160:161], v[224:225], v[64:67]
    s_waitcnt lgkmcnt(14)
    v_mfma_f32_16x16x16_bf16 v[68:71], v[162:163], v[224:225], v[68:71]
    s_waitcnt lgkmcnt(13)
    v_mfma_f32_16x16x16_bf16 v[72:75], v[164:165], v[224:225], v[72:75]
    s_waitcnt lgkmcnt(12)
    v_mfma_f32_16x16x16_bf16 v[76:79], v[166:167], v[224:225], v[76:79]
    s_waitcnt lgkmcnt(11)
    v_mfma_f32_16x16x16_bf16 v[80:83], v[168:169], v[224:225], v[80:83]
    s_waitcnt lgkmcnt(10)
    v_mfma_f32_16x16x16_bf16 v[84:87], v[170:171], v[224:225], v[84:87]
    s_waitcnt lgkmcnt(9)
    v_mfma_f32_16x16x16_bf16 v[88:91], v[172:173], v[224:225], v[88:91]
    s_waitcnt lgkmcnt(8)
    v_mfma_f32_16x16x16_bf16 v[92:95], v[174:175], v[224:225], v[92:95]
    s_waitcnt lgkmcnt(7)
    v_mfma_f32_16x16x16_bf16 v[96:99], v[176:177], v[224:225], v[96:99]
    s_waitcnt lgkmcnt(6)
    v_mfma_f32_16x16x16_bf16 v[100:103], v[178:179], v[224:225], v[100:103]
    s_waitcnt lgkmcnt(5)
    v_mfma_f32_16x16x16_bf16 v[104:107], v[180:181], v[224:225], v[104:107]
    s_waitcnt lgkmcnt(4)
    v_mfma_f32_16x16x16_bf16 v[108:111], v[182:183], v[224:225], v[108:111]
    s_waitcnt lgkmcnt(3)
    v_mfma_f32_16x16x16_bf16 v[112:115], v[184:185], v[224:225], v[112:115]
    s_waitcnt lgkmcnt(2)
    v_mfma_f32_16x16x16_bf16 v[116:119], v[186:187], v[224:225], v[116:119]
    s_waitcnt lgkmcnt(1)
    v_mfma_f32_16x16x16_bf16 v[120:123], v[188:189], v[224:225], v[120:123]
    s_waitcnt lgkmcnt(0)
    v_mfma_f32_16x16x16_bf16 v[124:127], v[190:191], v[224:225], v[124:127]
    s_cmp_lg_u32 s15, 1000
    s_cbranch_scc1 L_noiv_a
    s_add_u32 s11, s8, 8192
    s_mov_b32 m0, s11
    s_add_u32 s12, s8, 12288
    buffer_load_dwordx4 v200, s[48:51], s9 offen offset:0 nt lds
    buffer_load_dwordx4 v201, s[48:51], s9 offen offset:1024 nt lds
    buffer_load_dwordx4 v202, s[48:51], s9 offen offset:2048 nt lds
    buffer_load_dwordx4 v203, s[48:51], s9 offen offset:3072 nt lds
    s_mov_b32 m0, s12
    s_nop 0
    buffer_load_dwordx4 v204, s[48:51], s9 offen offset:0 nt lds
    buffer_load_dwordx4 v205, s[48:51], s9 offen offset:1024 nt lds
    buffer_load_dwordx4 v206, s[48:51], s9 offen offset:2048 nt lds
    buffer_load_dwordx4 v207, s[48:51], s9 offen offset:3072 nt lds
L_noiv_a:
    s_add_u32 s13, s13, 1
    s_cmp_ge_u32 s13, s15
    s_cbranch_scc1 L_loop_done
    s_cmp_eq_u32 s15, 1000
    s_cbranch_scc1 L_wk_b
    s_waitcnt vmcnt(0)
L_wk_b:
    s_waitcnt vmcnt(24)
    v_mov_b32 v237, s13
    ds_read_b32 v236, v235
    ds_write_b32 v238, v237
    ds_read_b128 v[128:131], v208 offset:16384
    ds_read_b128 v[132:135], v209 offset:16384
    ds_read_b128 v[136:139], v210 offset:16384
    ds_read_b128 v[140:143], v211 offset:16384
    ds_read_b128 v[144:147], v208 offset:16640
    ds_read_b128 v[148:151], v209 offset:16640
    ds_read_b128 v[152:155], v210 offset:16640
    ds_read_b128 v[156:159], v211 offset:16640
    s_waitcnt lgkmcnt(7)
    v_mfma_f32_16x16x32_bf16 v[220:223], v[128:131], v[16:19], 0
    s_waitcnt lgkmcnt(6)
    v_mfma_f32_16x16x32_bf16 v[220:223], v[132:135], v[20:23], v[220:223]
    s_waitcnt lgkmcnt(5)
    v_mfma_f32_16x16x32_bf16 v[220:223], v[136:139], v[24:27], v[220:223]
    s_waitcnt lgkmcnt(4)
    v_mfma_f32_16x16x32_bf16 v[220:223], v[140:143], v[28:31], v[220:223]
    s_waitcnt lgkmcnt(3)
    v_mfma_f32_16x16x32_bf16 v[220:223], v[144:147], v[32:35], v[220:223]
    s_waitcnt lgkmcnt(2)
    v_mfma_f32_16x16x32_bf16 v[220:223], v[148:151], v[36:39], v[220:223]
    s_waitcnt lgkmcnt(1)
    v_mfma_f32_16x16x32_bf16 v[220:223], v[152:155], v[40:43], v[220:223]
    s_waitcnt lgkmcnt(0)
    v_mfma_f32_16x16x32_bf16 v[220:223], v[156:159], v[44:47], v[220:223]
    v_readfirstlane_b32 s6, v236
    s_cmp_lg_u32 s6, -1
    s_cbranch_scc1 L_nx_b
L_nxs_b:
    s_sleep 1
    ds_read_b32 v236, v235
    s_waitcnt lgkmcnt(0)
    v_readfirstlane_b32 s6, v236
    s_cmp_eq_u32 s6, -1
    s_cbranch_scc1 L_nxs_b
L_nx_b:
    v_add_u32 v235, 4, v235
    s_lshl_b32 s7, s6, 15
    s_add_u32 s9, s20, s7
    s_add_u32 s7, s13, 2
    s_min_u32 s7, s7, s15
    s_cmp_ge_u32 s6, 128
    s_cselect_b32 s15, s7, s15
    s_cbranch_scc1 L_noik_b
    s_add_u32 s11, s8, 16384
    s_mov_b32 m0, s11
    s_add_u32 s12, s8, 20480
    buffer_load_dwordx4 v192, s[44:47], s9 offen offset:0 nt lds
    buffer_load_dwordx4 v193, s[44:47], s9 offen offset:1024 nt lds
    buffer_load_dwordx4 v194, s[44:47], s9 offen offset:2048 nt lds
    buffer_load_dwordx4 v195, s[44:47], s9 offen offset:3072 nt lds
    s_mov_b32 m0, s12
    s_nop 0
    buffer_load_dwordx4 v196, s[44:47], s9 offen offset:0 nt lds
    buffer_load_dwordx4 v197, s[44:47], s9 offen offset:1024 nt lds
    buffer_load_dwordx4 v198, s[44:47], s9 offen offset:2048 nt lds
    buffer_load_dwordx4 v199, s[44:47], s9 offen offset:3072 nt lds
L_noik_b:
    s_nop 3
    v_cvt_pk_bf16_f32 v229, v220, v221
    v_cvt_pk_bf16_f32 v230, v222, v223
    v_lshlrev_b32 v220, 16, v229
    v_and_b32 v221, 0xffff0000, v229
    v_lshlrev_b32 v222, 16, v230
    v_and_b32 v223, 0xffff0000, v230
    v_max3_f32 v229, v220, v221, v222
    v_max_f32 v229, v229, v223
    v_mov_b32 v230, v229
    s_nop 1
    v_permlane16_swap_b32 v229, v230
    s_nop 1
    v_max_f32 v229, v229, v230
    v_mov_b32 v230, v229
    s_nop 1
    v_permlane32_swap_b32 v229, v230
    s_nop 1
    v_max_f32 v229, v229, v230
    v_mul_f32 v229, s14, v229
    v_max_f32 v229, v229, v226
    v_sub_f32 v228, v226, v229
    v_exp_f32 v228, v228
    v_mov_b32 v226, v229
    v_fma_f32 v220, v220, s14, -v229
    v_fma_f32 v221, v221, s14, -v229
    v_fma_f32 v222, v222, s14, -v229
    v_fma_f32 v223, v223, s14, -v229
    v_exp_f32 v220, v220
    v_exp_f32 v221, v221
    v_exp_f32 v222, v222
    v_exp_f32 v223, v223
    v_cmp_neq_f32 vcc, 1.0, v228
    v_cvt_pk_bf16_f32 v224, v220, v221
    v_cvt_pk_bf16_f32 v225, v222, v223
    v_add_f32 v230, v220, v221
    v_add_f32 v231, v222, v223
    v_add_f32 v230, v230, v231
    v_fma_f32 v227, v227, v228, v230
    s_cbranch_vccz L_nors_b
    v_mul_f32 v64, v64, v228
    v_mul_f32 v65, v65, v228
    v_mul_f32 v66, v66, v228
    v_mul_f32 v67, v67, v228
    v_mul_f32 v68, v68, v228
    v_mul_f32 v69, v69, v228
    v_mul_f32 v70, v70, v228
    v_mul_f32 v71, v71, v228
    v_mul_f32 v72, v72, v228
    v_mul_f32 v73, v73, v228
    v_mul_f32 v74, v74, v228
    v_mul_f32 v75, v75, v228
    v_mul_f32 v76, v76, v228
    v_mul_f32 v77, v77, v228
    v_mul_f32 v78, v78, v228
    v_mul_f32 v79, v79, v228
    v_mul_f32 v80, v80, v228
    v_mul_f32 v81, v81, v228
    v_mul_f32 v82, v82, v228
    v_mul_f32 v83, v83, v228
    v_mul_f32 v84, v84, v228
    v_mul_f32 v85, v85, v228
    v_mul_f32 v86, v86, v228
    v_mul_f32 v87, v87, v228
    v_mul_f32 v88, v88, v228
    v_mul_f32 v89, v89, v228
    v_mul_f32 v90, v90, v228
    v_mul_f32 v91, v91, v228
    v_mul_f32 v92, v92, v228
    v_mul_f32 v93, v93, v228
    v_mul_f32 v94, v94, v228
    v_mul_f32 v95, v95, v228
    v_mul_f32 v96, v96, v228
    v_mul_f32 v97, v97, v228
    v_mul_f32 v98, v98, v228
    v_mul_f32 v99, v99, v228
    v_mul_f32 v100, v100, v228
    v_mul_f32 v101, v101, v228
    v_mul_f32 v102, v102, v228
    v_mul_f32 v103, v103, v228
    v_mul_f32 v104, v104, v228
    v_mul_f32 v105, v105, v228
    v_mul_f32 v106, v106, v228
    v_mul_f32 v107, v107, v228
    v_mul_f32 v108, v108, v228
    v_mul_f32 v109, v109, v228
    v_mul_f32 v110, v110, v228
    v_mul_f32 v111, v111, v228
    v_mul_f32 v112, v112, v228
    v_mul_f32 v113, v113, v228
    v_mul_f32 v114, v114, v228
    v_mul_f32 v115, v115, v228
    v_mul_f32 v116, v116, v228
    v_mul_f32 v117, v117, v228
    v_mul_f32 v118, v118, v228
    v_mul_f32 v119, v119, v228
    v_mul_f32 v120, v120, v228
    v_mul_f32 v121, v121, v228
    v_mul_f32 v122, v122, v228
    v_mul_f32 v123, v123, v228
    v_mul_f32 v124, v124, v228
    v_mul_f32 v125, v125, v228
    v_mul_f32 v126, v126, v228
    v_mul_f32 v127, v127, v228
L_nors_b:
    s_cmp_eq_u32 s15, 1000
    s_cbranch_scc1 L_wv_b
    s_waitcnt vmcnt(0)
L_wv_b:
    s_waitcnt vmcnt(24)
    ds_read_b64_tr_b16 v[160:161], v212 offset:24576
    ds_read_b64_tr_b16 v[162:163], v213 offset:24576
    ds_read_b64_tr_b16 v[164:165], v214 offset:24576
    ds_read_b64_tr_b16 v[166:167], v215 offset:24576
    ds_read_b64_tr_b16 v[168:169], v216 offset:24576
    ds_read_b64_tr_b16 v[170:171], v217 offset:24576
    ds_read_b64_tr_b16 v[172:173], v218 offset:24576
    ds_read_b64_tr_b16 v[174:175], v219 offset:24576
    ds_read_b64_tr_b16 v[176:177], v212 offset:24832
    ds_read_b64_tr_b16 v[178:179], v213 offset:24832
    ds_read_b64_tr_b16 v[180:181], v214 offset:24832
    ds_read_b64_tr_b16 v[182:183], v215 offset:24832
    ds_read_b64_tr_b16 v[184:185], v216 offset:24832
    ds_read_b64_tr_b16 v[186:187], v217 offset:24832
    ds_read_b64_tr_b16 v[188:189], v218 offset:24832
    ds_read_b64_tr_b16 v[190:191], v219 offset:24832
    s_waitcnt lgkmcnt(15)
    v_mfma_f32_16x16x16_bf16 v[64:67], v[160:161], v[224:225], v[64:67]
    s_waitcnt lgkmcnt(14)
    v_mfma_f32_16x16x16_bf16 v[68:71], v[162:163], v[224:225], v[68:71]
    s_waitcnt lgkmcnt(13)
    v_mfma_f32_16x16x16_bf16 v[72:75], v[164:165], v[224:225], v[72:75]
    s_waitcnt lgkmcnt(12)
    v_mfma_f32_16x16x16_bf16 v[76:79], v[166:167], v[224:225], v[76:79]
    s_waitcnt lgkmcnt(11)
    v_mfma_f32_16x16x16_bf16 v[80:83], v[168:169], v[224:225], v[80:83]
    s_waitcnt lgkmcnt(10)
    v_mfma_f32_16x16x16_bf16 v[84:87], v[170:171], v[224:225], v[84:87]
    s_waitcnt lgkmcnt(9)
    v_mfma_f32_16x16x16_bf16 v[88:91], v[172:173], v[224:225], v[88:91]
    s_waitcnt lgkmcnt(8)
    v_mfma_f32_16x16x16_bf16 v[92:95], v[174:175], v[224:225], v[92:95]
    s_waitcnt lgkmcnt(7)
    v_mfma_f32_16x16x16_bf16 v[96:99], v[176:177], v[224:225], v[96:99]
    s_waitcnt lgkmcnt(6)
    v_mfma_f32_16x16x16_bf16 v[100:103], v[178:179], v[224:225], v[100:103]
    s_waitcnt lgkmcnt(5)
    v_mfma_f32_16x16x16_bf16 v[104:107], v[180:181], v[224:225], v[104:107]
    s_waitcnt lgkmcnt(4)
    v_mfma_f32_16x16x16_bf16 v[108:111], v[182:183], v[224:225], v[108:111]
    s_waitcnt lgkmcnt(3)
    v_mfma_f32_16x16x16_bf16 v[112:115], v[184:185], v[224:225], v[112:115]
    s_waitcnt lgkmcnt(2)
    v_mfma_f32_16x16x16_bf16 v[116:119], v[186:187], v[224:225], v[116:119]
    s_waitcnt lgkmcnt(1)
    v_mfma_f32_16x16x16_bf16 v[120:123], v[188:189], v[224:225], v[120:123]
    s_waitcnt lgkmcnt(0)
    v_mfma_f32_16x16x16_bf16 v[124:127], v[190:191], v[224:225], v[124:127]
    s_cmp_lg_u32 s15, 1000
    s_cbranch_scc1 L_noiv_b
    s_add_u32 s11, s8, 24576
    s_mov_b32 m0, s11
    s_add_u32 s12, s8, 28672
    buffer_load_dwordx4 v200, s[48:51], s9 offen offset:0 nt lds
    buffer_load_dwordx4 v201, s[48:51], s9 offen offset:1024 nt lds
    buffer_load_dwordx4 v202, s[48:51], s9 offen offset:2048 nt lds
    buffer_load_dwordx4 v203, s[48:51], s9 offen offset:3072 nt lds
    s_mov_b32 m0, s12
    s_nop 0
    buffer_load_dwordx4 v204, s[48:51], s9 offen offset:0 nt lds
    buffer_load_dwordx4 v205, s[48:51], s9 offen offset:1024 nt lds
    buffer_load_dwordx4 v206, s[48:51], s9 offen offset:2048 nt lds
    buffer_load_dwordx4 v207, s[48:51], s9 offen offset:3072 nt lds
L_noiv_b:
    s_add_u32 s13, s13, 1
    s_cmp_lt_u32 s13, s15
    s_cbranch_scc1 L_loop
L_loop_done:
    s_waitcnt vmcnt(0)
    v_mov_b32 v230, v227
    s_nop 1
    v_permlane16_swap_b32 v227, v230
    s_nop 1
    v_add_f32 v227, v227, v230
    v_mov_b32 v230, v227
    s_nop 1
    v_permlane32_swap_b32 v227, v230
    s_nop 1
    v_add_f32 v227, v227, v230
    s_nop 7
    v_cmp_gt_u32 vcc, 2, v3
    v_lshlrev_b32 v5, 10, v3
    v_lshl_add_u32 v5, v4, 4, v5
    v_add_u32 v5, s8, v5
    s_and_b64 exec, exec, vcc
    ds_write_b128 v5, v[64:67] offset:0
    ds_write_b128 v5, v[68:71] offset:64
    ds_write_b128 v5, v[72:75] offset:128
    ds_write_b128 v5, v[76:79] offset:192
    ds_write_b128 v5, v[80:83] offset:256
    ds_write_b128 v5, v[84:87] offset:320
    ds_write_b128 v5, v[88:91] offset:384
    ds_write_b128 v5, v[92:95] offset:448
    ds_write_b128 v5, v[96:99] offset:512
    ds_write_b128 v5, v[100:103] offset:576
    ds_write_b128 v5, v[104:107] offset:640
    ds_write_b128 v5, v[108:111] offset:704
    ds_write_b128 v5, v[112:115] offset:768
    ds_write_b128 v5, v[116:119] offset:832
    ds_write_b128 v5, v[120:123] offset:896
    ds_write_b128 v5, v[124:127] offset:960
    v_cmp_gt_u32 vcc, 2, v2
    v_lshlrev_b32 v5, 3, v2
    v_add_u32 v5, s8, v5
    s_and_b64 exec, exec, vcc
    ds_write_b64 v5, v[226:227] offset:2048
    s_mov_b64 exec, s[58:59]
    s_waitcnt lgkmcnt(0)
    s_barrier
    v_lshrrev_b32 v5, 7, v0
    v_lshlrev_b32 v6, 3, v5
    v_lshlrev_b32 v7, 3, v0
    v_add_u32 v9, 0x10000, v6
    v_add_u32 v10, 0x10000, v7
    ds_read_b64 v[16:17], v6 offset:2048
    ds_read_b64 v[24:25], v7 offset:0
    ds_read_b64 v[18:19], v6 offset:34816
    ds_read_b64 v[26:27], v7 offset:32768
    ds_read_b64 v[20:21], v9 offset:2048
    ds_read_b64 v[28:29], v10 offset:0
    ds_read_b64 v[22:23], v9 offset:34816
    ds_read_b64 v[30:31], v10 offset:32768
    s_waitcnt lgkmcnt(0)
    v_max_f32 v32, v16, v18
    v_max3_f32 v32, v32, v20, v22
    v_sub_f32 v16, v16, v32
    v_exp_f32 v16, v16
    v_sub_f32 v18, v18, v32
    v_exp_f32 v18, v18
    v_sub_f32 v20, v20, v32
    v_exp_f32 v20, v20
    v_sub_f32 v22, v22, v32
    v_exp_f32 v22, v22
    s_nop 0
    v_mul_f32 v33, v16, v17
    v_mul_f32 v34, v16, v24
    v_mul_f32 v35, v16, v25
    v_fmac_f32 v33, v18, v19
    v_fmac_f32 v34, v18, v26
    v_fmac_f32 v35, v18, v27
    v_fmac_f32 v33, v20, v21
    v_fmac_f32 v34, v20, v28
    v_fmac_f32 v35, v20, v29
    v_fmac_f32 v33, v22, v23
    v_fmac_f32 v34, v22, v30
    v_fmac_f32 v35, v22, v31
    s_lshl_b32 s6, s98, 11
    s_add_u32 s6, s6, 131072
    buffer_store_dwordx2 v[34:35], v7, s[52:55], s6 offen sc1
    v_and_b32 v8, 127, v0
    v_cmp_gt_u32 vcc, 16, v8
    v_lshlrev_b32 v8, 3, v8
    v_lshl_add_u32 v8, v5, 7, v8
    s_lshl_b32 s6, s98, 8
    s_add_u32 s6, s6, 655360
    s_and_b64 exec, exec, vcc
    s_cbranch_execz L_noml
    buffer_store_dwordx2 v[32:33], v8, s[52:55], s6 offen sc1
L_noml:
    s_mov_b64 exec, s[58:59]
    s_branch L_tail
L_tail:
    s_cmp_ge_u32 s38, 14
    s_cselect_b32 s99, 1, 0
    s_mul_i32 s6, s99, 14
    s_sub_u32 s100, s38, s6
    s_lshl_b32 s101, s4, 1
    s_add_u32 s101, s101, s99
    s_cmp_eq_u32 s3, 7
    s_cbranch_scc1 L_now
    v_mul_u32_u24 v5, 56, v2
    buffer_load_dwordx4 v[128:131], v5, s[80:83], 0 offen offset:0
    buffer_load_dwordx4 v[132:135], v5, s[80:83], 0 offen offset:16
    buffer_load_dwordx4 v[136:139], v5, s[80:83], 0 offen offset:32
    buffer_load_dwordx2 v[140:141], v5, s[80:83], 0 offen offset:48
    buffer_load_dwordx4 v[144:147], v5, s[84:87], 0 offen offset:0
    buffer_load_dwordx4 v[148:151], v5, s[84:87], 0 offen offset:16
    buffer_load_dwordx4 v[152:155], v5, s[84:87], 0 offen offset:32
    buffer_load_dwordx2 v[156:157], v5, s[84:87], 0 offen offset:48
    buffer_load_dwordx4 v[160:163], v5, s[88:91], 0 offen offset:0
    buffer_load_dwordx4 v[164:167], v5, s[88:91], 0 offen offset:16
    buffer_load_dwordx4 v[168:171], v5, s[88:91], 0 offen offset:32
    buffer_load_dwordx2 v[172:173], v5, s[88:91], 0 offen offset:48
    v_mov_b32 v6, 0
    buffer_load_ushort v174, v6, s[92:95], 0 offen
L_now:
    s_cmp_ge_u32 s38, 28
    s_cbranch_scc1 L_stageD
    s_cmp_ge_u32 s3, 4
    s_cbranch_scc1 L_bar4
    v_lshrrev_b32 v5, 5, v0
    v_and_b32 v6, 31, v0
    v_lshlrev_b32 v7, 13, v5
    v_lshl_add_u32 v7, v6, 5, v7
    v_lshlrev_b32 v8, 10, v5
    s_lshl_b32 s10, s4, 16
    s_lshl_b32 s11, s99, 10
    s_add_u32 s10, s10, s11
    s_add_u32 s10, s10, 131072
    s_add_u32 s11, s10, 4096
    s_lshl_b32 s12, s4, 13
    s_lshl_b32 s6, s99, 7
    s_add_u32 s12, s12, s6
    s_add_u32 s12, s12, 655360
    v_and_b32 v9, 31, v2
    v_lshlrev_b32 v9, 8, v9
    s_mov_b32 s13, 0
L_pollC0:
    buffer_load_dwordx2 v[16:17], v9, s[52:55], s12 offen sc1
    s_add_u32 s13, s13, 1
    s_waitcnt vmcnt(0)
    v_max_u32 v56, v16, v17
    v_cmp_eq_u32 vcc, -1, v56
    s_cmp_ge_u32 s13, 262144
    s_cbranch_scc1 L_pollC
    s_cbranch_vccz L_pollC
    s_sleep 8
    s_branch L_pollC0
L_pollC:
    buffer_load_dwordx2 v[48:49], v8, s[52:55], s12 offen offset:0 sc1
    buffer_load_dwordx2 v[50:51], v8, s[52:55], s12 offen offset:256 sc1
    buffer_load_dwordx2 v[52:53], v8, s[52:55], s12 offen offset:512 sc1
    buffer_load_dwordx2 v[54:55], v8, s[52:55], s12 offen offset:768 sc1
    buffer_load_dwordx4 v[16:19], v7, s[52:55], s10 offen offset:0 sc1
    buffer_load_dwordx4 v[20:23], v7, s[52:55], s10 offen offset:16 sc1
    buffer_load_dwordx4 v[24:27], v7, s[52:55], s10 offen offset:2048 sc1
    buffer_load_dwordx4 v[28:31], v7, s[52:55], s10 offen offset:2064 sc1
    buffer_load_dwordx4 v[32:35], v7, s[52:55], s11 offen offset:0 sc1
    buffer_load_dwordx4 v[36:39], v7, s[52:55], s11 offen offset:16 sc1
    buffer_load_dwordx4 v[40:43], v7, s[52:55], s11 offen offset:2048 sc1
    buffer_load_dwordx4 v[44:47], v7, s[52:55], s11 offen offset:2064 sc1
    s_add_u32 s13, s13, 1
    s_waitcnt vmcnt(0)
    v_max_u32 v56, v16, v17
    v_max3_u32 v56, v56, v18, v19
    v_max3_u32 v56, v56, v20, v21
    v_max3_u32 v56, v56, v22, v23
    v_max3_u32 v56, v56, v24, v25
    v_max3_u32 v56, v56, v26, v27
    v_max3_u32 v56, v56, v28, v29
    v_max3_u32 v56, v56, v30, v31
    v_max3_u32 v56, v56, v32, v33
    v_max3_u32 v56, v56, v34, v35
    v_max3_u32 v56, v56, v36, v37
    v_max3_u32 v56, v56, v38, v39
    v_max3_u32 v56, v56, v40, v41
    v_max3_u32 v56, v56, v42, v43
    v_max3_u32 v56, v56, v44, v45
    v_max3_u32 v56, v56, v46, v47
    v_max3_u32 v56, v56, v48, v49
    v_max3_u32 v56, v56, v50, v51
    v_max3_u32 v56, v56, v52, v53
    v_max3_u32 v56, v56, v54, v55
    v_cmp_eq_u32 vcc, -1, v56
    s_cmp_ge_u32 s13, 262144
    s_cbranch_scc1 L_pollC_done
    s_cbranch_vccz L_pollC_done
    s_sleep 4
    s_branch L_pollC
L_pollC_done:
    v_max_f32 v56, v48, v50
    v_max3_f32 v56, v56, v52, v54
    v_sub_f32 v48, v48, v56
    v_exp_f32 v48, v48
    v_sub_f32 v50, v50, v56
    v_exp_f32 v50, v50
    v_sub_f32 v52, v52, v56
    v_exp_f32 v52, v52
    v_sub_f32 v54, v54, v56
    v_exp_f32 v54, v54
    s_nop 0
    v_mul_f32 v57, v48, v49
    v_fmac_f32 v57, v50, v51
    v_fmac_f32 v57, v52, v53
    v_fmac_f32 v57, v54, v55
    v_rcp_f32 v57, v57
    s_nop 0
    v_mul_f32 v48, v48, v57
    v_mul_f32 v50, v50, v57
    v_mul_f32 v52, v52, v57
    v_mul_f32 v54, v54, v57
    v_mul_f32 v60, v48, v16
    v_fmac_f32 v60, v50, v24
    v_fmac_f32 v60, v52, v32
    v_fmac_f32 v60, v54, v40
    v_mul_f32 v61, v48, v17
    v_fmac_f32 v61, v50, v25
    v_fmac_f32 v61, v52, v33
    v_fmac_f32 v61, v54, v41
    v_mul_f32 v62, v48, v18
    v_fmac_f32 v62, v50, v26
    v_fmac_f32 v62, v52, v34
    v_fmac_f32 v62, v54, v42
    v_mul_f32 v63, v48, v19
    v_fmac_f32 v63, v50, v27
    v_fmac_f32 v63, v52, v35
    v_fmac_f32 v63, v54, v43
    v_mul_f32 v64, v48, v20
    v_fmac_f32 v64, v50, v28
    v_fmac_f32 v64, v52, v36
    v_fmac_f32 v64, v54, v44
    v_mul_f32 v65, v48, v21
    v_fmac_f32 v65, v50, v29
    v_fmac_f32 v65, v52, v37
    v_fmac_f32 v65, v54, v45
    v_mul_f32 v66, v48, v22
    v_fmac_f32 v66, v50, v30
    v_fmac_f32 v66, v52, v38
    v_fmac_f32 v66, v54, v46
    v_mul_f32 v67, v48, v23
    v_fmac_f32 v67, v50, v31
    v_fmac_f32 v67, v52, v39
    v_fmac_f32 v67, v54, v47
    v_cvt_pk_bf16_f32 v68, v60, v61
    v_cvt_pk_bf16_f32 v69, v62, v63
    v_cvt_pk_bf16_f32 v70, v64, v65
    v_cvt_pk_bf16_f32 v71, v66, v67
    v_lshlrev_b32 v6, 4, v0
    v_add_u32 v6, 153600, v6
    ds_write_b128 v6, v[68:71]
    s_waitcnt lgkmcnt(0)
L_bar4:
    s_barrier
    s_cmp_lg_u32 s3, 0
    s_cbranch_scc1 L_stageD
    v_bfe_u32 v5, v2, 2, 2
    v_lshl_add_u32 v5, v4, 3, v5
    v_lshlrev_b32 v5, 6, v5
    v_and_b32 v6, 3, v2
    v_lshl_add_u32 v5, v6, 3, v5
    v_add_u32 v5, 131072, v5
    v_and_b32 v6, 7, v2
    v_lshlrev_b32 v6, 9, v6
    v_lshl_add_u32 v6, v4, 4, v6
    v_add_u32 v6, 153600, v6
    ds_read_b128 v[48:51], v6 offset:0
    ds_read_b64_tr_b16 v[16:17], v5 offset:0
    ds_read_b64_tr_b16 v[18:19], v5 offset:256
    ds_read_b64_tr_b16 v[88:89], v5 offset:32
    ds_read_b64_tr_b16 v[90:91], v5 offset:288
    ds_read_b128 v[52:55], v6 offset:64
    ds_read_b64_tr_b16 v[20:21], v5 offset:2048
    ds_read_b64_tr_b16 v[22:23], v5 offset:2304
    ds_read_b64_tr_b16 v[92:93], v5 offset:2080
    ds_read_b64_tr_b16 v[94:95], v5 offset:2336
    ds_read_b128 v[56:59], v6 offset:128
    ds_read_b64_tr_b16 v[24:25], v5 offset:4096
    ds_read_b64_tr_b16 v[26:27], v5 offset:4352
    ds_read_b64_tr_b16 v[96:97], v5 offset:4128
    ds_read_b64_tr_b16 v[98:99], v5 offset:4384
    ds_read_b128 v[60:63], v6 offset:192
    ds_read_b64_tr_b16 v[28:29], v5 offset:6144
    ds_read_b64_tr_b16 v[30:31], v5 offset:6400
    ds_read_b64_tr_b16 v[100:101], v5 offset:6176
    ds_read_b64_tr_b16 v[102:103], v5 offset:6432
    ds_read_b128 v[64:67], v6 offset:256
    ds_read_b64_tr_b16 v[32:33], v5 offset:8192
    ds_read_b64_tr_b16 v[34:35], v5 offset:8448
    ds_read_b64_tr_b16 v[104:105], v5 offset:8224
    ds_read_b64_tr_b16 v[106:107], v5 offset:8480
    ds_read_b128 v[68:71], v6 offset:320
    ds_read_b64_tr_b16 v[36:37], v5 offset:10240
    ds_read_b64_tr_b16 v[38:39], v5 offset:10496
    ds_read_b64_tr_b16 v[108:109], v5 offset:10272
    ds_read_b64_tr_b16 v[110:111], v5 offset:10528
    ds_read_b128 v[72:75], v6 offset:384
    ds_read_b64_tr_b16 v[40:41], v5 offset:12288
    ds_read_b64_tr_b16 v[42:43], v5 offset:12544
    ds_read_b64_tr_b16 v[112:113], v5 offset:12320
    ds_read_b64_tr_b16 v[114:115], v5 offset:12576
    ds_read_b128 v[76:79], v6 offset:448
    ds_read_b64_tr_b16 v[44:45], v5 offset:14336
    ds_read_b64_tr_b16 v[46:47], v5 offset:14592
    ds_read_b64_tr_b16 v[116:117], v5 offset:14368
    ds_read_b64_tr_b16 v[118:119], v5 offset:14624
    s_waitcnt lgkmcnt(0)
    v_mfma_f32_16x16x32_bf16 v[80:83], v[16:19], v[48:51], 0
    v_mfma_f32_16x16x32_bf16 v[84:87], v[88:91], v[48:51], 0
    v_mfma_f32_16x16x32_bf16 v[80:83], v[20:23], v[52:55], v[80:83]
    v_mfma_f32_16x16x32_bf16 v[84:87], v[92:95], v[52:55], v[84:87]
    v_mfma_f32_16x16x32_bf16 v[80:83], v[24:27], v[56:59], v[80:83]
    v_mfma_f32_16x16x32_bf16 v[84:87], v[96:99], v[56:59], v[84:87]
    v_mfma_f32_16x16x32_bf16 v[80:83], v[28:31], v[60:63], v[80:83]
    v_mfma_f32_16x16x32_bf16 v[84:87], v[100:103], v[60:63], v[84:87]
    v_mfma_f32_16x16x32_bf16 v[80:83], v[32:35], v[64:67], v[80:83]
    v_mfma_f32_16x16x32_bf16 v[84:87], v[104:107], v[64:67], v[84:87]
    v_mfma_f32_16x16x32_bf16 v[80:83], v[36:39], v[68:71], v[80:83]
    v_mfma_f32_16x16x32_bf16 v[84:87], v[108:111], v[68:71], v[84:87]
    v_mfma_f32_16x16x32_bf16 v[80:83], v[40:43], v[72:75], v[80:83]
    v_mfma_f32_16x16x32_bf16 v[84:87], v[112:115], v[72:75], v[84:87]
    v_mfma_f32_16x16x32_bf16 v[80:83], v[44:47], v[76:79], v[80:83]
    v_mfma_f32_16x16x32_bf16 v[84:87], v[116:119], v[76:79], v[84:87]
    v_cmp_gt_u32 vcc, 8, v3
    v_lshlrev_b32 v5, 7, v3
    v_lshl_add_u32 v5, v4, 4, v5
    v_add_u32 v5, 152576, v5
    v_lshlrev_b32 v6, 4, v2
    v_add_u32 v7, 152576, v6
    s_lshl_b32 s6, s4, 1
    s_mul_i32 s6, s6, 14
    s_add_u32 s6, s6, s38
    s_lshl_b32 s6, s6, 10
    s_add_u32 s6, s6, 720896
    s_and_b64 exec, exec, vcc
    ds_write_b128 v5, v[80:83]
    ds_write_b128 v5, v[84:87] offset:64
    s_mov_b64 exec, s[58:59]
    s_waitcnt lgkmcnt(0)
    ds_read_b128 v[80:83], v7
    s_waitcnt lgkmcnt(0)
    buffer_store_dwordx4 v[80:83], v6, s[52:55], s6 offen sc1
L_stageD:
    s_lshr_b32 s96, s2, 5
    s_and_b32 s97, s2, 31
    s_cmp_lg_u32 s3, 7
    s_cbranch_scc1 L_bar5
    v_lshrrev_b32 v5, 2, v2
    v_lshlrev_b32 v5, 10, v5
    v_and_b32 v6, 3, v2
    v_lshl_add_u32 v5, v6, 5, v5
    v_mov_b32 v6, 0x7fff0000
    v_cndmask_b32 v5, v6, v5, s[56:57]
    v_lshlrev_b32 v7, 4, v2
    v_cndmask_b32 v7, v6, v7, s[56:57]
    s_mul_i32 s6, s96, 896
    buffer_load_dwordx4 v[8:11], v7, s[60:63], s6 offen
    s_mov_b32 s13, 0
L_pollD:
    s_lshl_b32 s6, s96, 7
    s_add_u32 s6, s6, 720896
    buffer_load_dwordx4 v[128:131], v5, s[52:55], s6 offen sc1
    buffer_load_dwordx4 v[132:135], v5, s[52:55], s6 offen offset:16 sc1
    s_add_u32 s6, s6, 14336
    buffer_load_dwordx4 v[136:139], v5, s[52:55], s6 offen sc1
    buffer_load_dwordx4 v[140:143], v5, s[52:55], s6 offen offset:16 sc1
    s_add_u32 s6, s6, 14336
    buffer_load_dwordx4 v[144:147], v5, s[52:55], s6 offen sc1
    buffer_load_dwordx4 v[148:151], v5, s[52:55], s6 offen offset:16 sc1
    s_add_u32 s6, s6, 14336
    buffer_load_dwordx4 v[152:155], v5, s[52:55], s6 offen sc1
    buffer_load_dwordx4 v[156:159], v5, s[52:55], s6 offen offset:16 sc1
    s_add_u32 s6, s6, 14336
    buffer_load_dwordx4 v[160:163], v5, s[52:55], s6 offen sc1
    buffer_load_dwordx4 v[164:167], v5, s[52:55], s6 offen offset:16 sc1
    s_add_u32 s6, s6, 14336
    buffer_load_dwordx4 v[168:171], v5, s[52:55], s6 offen sc1
    buffer_load_dwordx4 v[172:175], v5, s[52:55], s6 offen offset:16 sc1
    s_add_u32 s6, s6, 14336
    buffer_load_dwordx4 v[176:179], v5, s[52:55], s6 offen sc1
    buffer_load_dwordx4 v[180:183], v5, s[52:55], s6 offen offset:16 sc1
    s_add_u32 s6, s6, 14336
    buffer_load_dwordx4 v[184:187], v5, s[52:55], s6 offen sc1
    buffer_load_dwordx4 v[188:191], v5, s[52:55], s6 offen offset:16 sc1
    s_add_u32 s6, s6, 14336
    buffer_load_dwordx4 v[192:195], v5, s[52:55], s6 offen sc1
    buffer_load_dwordx4 v[196:199], v5, s[52:55], s6 offen offset:16 sc1
    s_add_u32 s6, s6, 14336
    buffer_load_dwordx4 v[200:203], v5, s[52:55], s6 offen sc1
    buffer_load_dwordx4 v[204:207], v5, s[52:55], s6 offen offset:16 sc1
    s_add_u32 s6, s6, 14336
    buffer_load_dwordx4 v[208:211], v5, s[52:55], s6 offen sc1
    buffer_load_dwordx4 v[212:215], v5, s[52:55], s6 offen offset:16 sc1
    s_add_u32 s6, s6, 14336
    buffer_load_dwordx4 v[216:219], v5, s[52:55], s6 offen sc1
    buffer_load_dwordx4 v[220:223], v5, s[52:55], s6 offen offset:16 sc1
    s_add_u32 s6, s6, 14336
    buffer_load_dwordx4 v[224:227], v5, s[52:55], s6 offen sc1
    buffer_load_dwordx4 v[228:231], v5, s[52:55], s6 offen offset:16 sc1
    s_add_u32 s6, s6, 14336
    buffer_load_dwordx4 v[232:235], v5, s[52:55], s6 offen sc1
    buffer_load_dwordx4 v[236:239], v5, s[52:55], s6 offen offset:16 sc1
    s_add_u32 s6, s6, 14336
    buffer_load_dwordx4 v[240:243], v5, s[52:55], s6 offen sc1
    buffer_load_dwordx4 v[244:247], v5, s[52:55], s6 offen offset:16 sc1
    s_add_u32 s6, s6, 14336
    buffer_load_dwordx4 v[248:251], v5, s[52:55], s6 offen sc1
    buffer_load_dwordx4 v[252:255], v5, s[52:55], s6 offen offset:16 sc1
    s_add_u32 s6, s6, 14336
    s_add_u32 s13, s13, 1
    s_waitcnt vmcnt(0)
    v_max_u32 v12, v128, v129
    v_max3_u32 v12, v12, v130, v131
    v_max3_u32 v12, v12, v132, v133
    v_max3_u32 v12, v12, v134, v135
    v_max3_u32 v12, v12, v136, v137
    v_max3_u32 v12, v12, v138, v139
    v_max3_u32 v12, v12, v140, v141
    v_max3_u32 v12, v12, v142, v143
    v_max3_u32 v12, v12, v144, v145
    v_max3_u32 v12, v12, v146, v147
    v_max3_u32 v12, v12, v148, v149
    v_max3_u32 v12, v12, v150, v151
    v_max3_u32 v12, v12, v152, v153
    v_max3_u32 v12, v12, v154, v155
    v_max3_u32 v12, v12, v156, v157
    v_max3_u32 v12, v12, v158, v159
    v_max3_u32 v12, v12, v160, v161
    v_max3_u32 v12, v12, v162, v163
    v_max3_u32 v12, v12, v164, v165
    v_max3_u32 v12, v12, v166, v167
    v_max3_u32 v12, v12, v168, v169
    v_max3_u32 v12, v12, v170, v171
    v_max3_u32 v12, v12, v172, v173
    v_max3_u32 v12, v12, v174, v175
    v_max3_u32 v12, v12, v176, v177
    v_max3_u32 v12, v12, v178, v179
    v_max3_u32 v12, v12, v180, v181
    v_max3_u32 v12, v12, v182, v183
    v_max3_u32 v12, v12, v184, v185
    v_max3_u32 v12, v12, v186, v187
    v_max3_u32 v12, v12, v188, v189
    v_max3_u32 v12, v12, v190, v191
    v_max3_u32 v12, v12, v192, v193
    v_max3_u32 v12, v12, v194, v195
    v_max3_u32 v12, v12, v196, v197
    v_max3_u32 v12, v12, v198, v199
    v_max3_u32 v12, v12, v200, v201
    v_max3_u32 v12, v12, v202, v203
    v_max3_u32 v12, v12, v204, v205
    v_max3_u32 v12, v12, v206, v207
    v_max3_u32 v12, v12, v208, v209
    v_max3_u32 v12, v12, v210, v211
    v_max3_u32 v12, v12, v212, v213
    v_max3_u32 v12, v12, v214, v215
    v_max3_u32 v12, v12, v216, v217
    v_max3_u32 v12, v12, v218, v219
    v_max3_u32 v12, v12, v220, v221
    v_max3_u32 v12, v12, v222, v223
    v_max3_u32 v12, v12, v224, v225
    v_max3_u32 v12, v12, v226, v227
    v_max3_u32 v12, v12, v228, v229
    v_max3_u32 v12, v12, v230, v231
    v_max3_u32 v12, v12, v232, v233
    v_max3_u32 v12, v12, v234, v235
    v_max3_u32 v12, v12, v236, v237
    v_max3_u32 v12, v12, v238, v239
    v_max3_u32 v12, v12, v240, v241
    v_max3_u32 v12, v12, v242, v243
    v_max3_u32 v12, v12, v244, v245
    v_max3_u32 v12, v12, v246, v247
    v_max3_u32 v12, v12, v248, v249
    v_max3_u32 v12, v12, v250, v251
    v_max3_u32 v12, v12, v252, v253
    v_max3_u32 v12, v12, v254, v255
    v_cmp_eq_u32 vcc, -1, v12
    s_cmp_ge_u32 s13, 262144
    s_cbranch_scc1 L_pollD_done
    s_cbranch_vccz L_pollD_done
    s_sleep 4
    s_branch L_pollD
L_pollD_done:
    v_add_f32 v128, v128, v136
    v_add_f32 v129, v129, v137
    v_add_f32 v130, v130, v138
    v_add_f32 v131, v131, v139
    v_add_f32 v132, v132, v140
    v_add_f32 v133, v133, v141
    v_add_f32 v134, v134, v142
    v_add_f32 v135, v135, v143
    v_add_f32 v128, v128, v144
    v_add_f32 v129, v129, v145
    v_add_f32 v130, v130, v146
    v_add_f32 v131, v131, v147
    v_add_f32 v132, v132, v148
    v_add_f32 v133, v133, v149
    v_add_f32 v134, v134, v150
    v_add_f32 v135, v135, v151
    v_add_f32 v128, v128, v152
    v_add_f32 v129, v129, v153
    v_add_f32 v130, v130, v154
    v_add_f32 v131, v131, v155
    v_add_f32 v132, v132, v156
    v_add_f32 v133, v133, v157
    v_add_f32 v134, v134, v158
    v_add_f32 v135, v135, v159
    v_add_f32 v128, v128, v160
    v_add_f32 v129, v129, v161
    v_add_f32 v130, v130, v162
    v_add_f32 v131, v131, v163
    v_add_f32 v132, v132, v164
    v_add_f32 v133, v133, v165
    v_add_f32 v134, v134, v166
    v_add_f32 v135, v135, v167
    v_add_f32 v128, v128, v168
    v_add_f32 v129, v129, v169
    v_add_f32 v130, v130, v170
    v_add_f32 v131, v131, v171
    v_add_f32 v132, v132, v172
    v_add_f32 v133, v133, v173
    v_add_f32 v134, v134, v174
    v_add_f32 v135, v135, v175
    v_add_f32 v128, v128, v176
    v_add_f32 v129, v129, v177
    v_add_f32 v130, v130, v178
    v_add_f32 v131, v131, v179
    v_add_f32 v132, v132, v180
    v_add_f32 v133, v133, v181
    v_add_f32 v134, v134, v182
    v_add_f32 v135, v135, v183
    v_add_f32 v128, v128, v184
    v_add_f32 v129, v129, v185
    v_add_f32 v130, v130, v186
    v_add_f32 v131, v131, v187
    v_add_f32 v132, v132, v188
    v_add_f32 v133, v133, v189
    v_add_f32 v134, v134, v190
    v_add_f32 v135, v135, v191
    v_add_f32 v128, v128, v192
    v_add_f32 v129, v129, v193
    v_add_f32 v130, v130, v194
    v_add_f32 v131, v131, v195
    v_add_f32 v132, v132, v196
    v_add_f32 v133, v133, v197
    v_add_f32 v134, v134, v198
    v_add_f32 v135, v135, v199
    v_add_f32 v128, v128, v200
    v_add_f32 v129, v129, v201
    v_add_f32 v130, v130, v202
    v_add_f32 v131, v131, v203
    v_add_f32 v132, v132, v204
    v_add_f32 v133, v133, v205
    v_add_f32 v134, v134, v206
    v_add_f32 v135, v135, v207
    v_add_f32 v128, v128, v208
    v_add_f32 v129, v129, v209
    v_add_f32 v130, v130, v210
    v_add_f32 v131, v131, v211
    v_add_f32 v132, v132, v212
    v_add_f32 v133, v133, v213
    v_add_f32 v134, v134, v214
    v_add_f32 v135, v135, v215
    v_add_f32 v128, v128, v216
    v_add_f32 v129, v129, v217
    v_add_f32 v130, v130, v218
    v_add_f32 v131, v131, v219
    v_add_f32 v132, v132, v220
    v_add_f32 v133, v133, v221
    v_add_f32 v134, v134, v222
    v_add_f32 v135, v135, v223
    v_add_f32 v128, v128, v224
    v_add_f32 v129, v129, v225
    v_add_f32 v130, v130, v226
    v_add_f32 v131, v131, v227
    v_add_f32 v132, v132, v228
    v_add_f32 v133, v133, v229
    v_add_f32 v134, v134, v230
    v_add_f32 v135, v135, v231
    v_add_f32 v128, v128, v232
    v_add_f32 v129, v129, v233
    v_add_f32 v130, v130, v234
    v_add_f32 v131, v131, v235
    v_add_f32 v132, v132, v236
    v_add_f32 v133, v133, v237
    v_add_f32 v134, v134, v238
    v_add_f32 v135, v135, v239
    v_add_f32 v128, v128, v240
    v_add_f32 v129, v129, v241
    v_add_f32 v130, v130, v242
    v_add_f32 v131, v131, v243
    v_add_f32 v132, v132, v244
    v_add_f32 v133, v133, v245
    v_add_f32 v134, v134, v246
    v_add_f32 v135, v135, v247
    v_add_f32 v128, v128, v248
    v_add_f32 v129, v129, v249
    v_add_f32 v130, v130, v250
    v_add_f32 v131, v131, v251
    v_add_f32 v132, v132, v252
    v_add_f32 v133, v133, v253
    v_add_f32 v134, v134, v254
    v_add_f32 v135, v135, v255
    v_lshlrev_b32 v16, 16, v8
    v_and_b32 v17, 0xffff0000, v8
    v_lshlrev_b32 v18, 16, v9
    v_and_b32 v19, 0xffff0000, v9
    v_lshlrev_b32 v20, 16, v10
    v_and_b32 v21, 0xffff0000, v10
    v_lshlrev_b32 v22, 16, v11
    v_and_b32 v23, 0xffff0000, v11
    v_cvt_pk_bf16_f32 v12, v128, v129
    v_lshlrev_b32 v128, 16, v12
    v_and_b32 v129, 0xffff0000, v12
    v_add_f32 v16, v16, v128
    v_add_f32 v17, v17, v129
    v_cvt_pk_bf16_f32 v12, v16, v17
    v_lshlrev_b32 v16, 16, v12
    v_and_b32 v17, 0xffff0000, v12
    v_cvt_pk_bf16_f32 v12, v130, v131
    v_lshlrev_b32 v130, 16, v12
    v_and_b32 v131, 0xffff0000, v12
    v_add_f32 v18, v18, v130
    v_add_f32 v19, v19, v131
    v_cvt_pk_bf16_f32 v12, v18, v19
    v_lshlrev_b32 v18, 16, v12
    v_and_b32 v19, 0xffff0000, v12
    v_cvt_pk_bf16_f32 v12, v132, v133
    v_lshlrev_b32 v132, 16, v12
    v_and_b32 v133, 0xffff0000, v12
    v_add_f32 v20, v20, v132
    v_add_f32 v21, v21, v133
    v_cvt_pk_bf16_f32 v12, v20, v21
    v_lshlrev_b32 v20, 16, v12
    v_and_b32 v21, 0xffff0000, v12
    v_cvt_pk_bf16_f32 v12, v134, v135
    v_lshlrev_b32 v134, 16, v12
    v_and_b32 v135, 0xffff0000, v12
    v_add_f32 v22, v22, v134
    v_add_f32 v23, v23, v135
    v_cvt_pk_bf16_f32 v12, v22, v23
    v_lshlrev_b32 v22, 16, v12
    v_and_b32 v23, 0xffff0000, v12
    v_lshlrev_b32 v5, 5, v2
    v_add_u32 v5, 157696, v5
    s_mov_b64 exec, s[56:57]
    ds_write_b128 v5, v[16:19]
    ds_write_b128 v5, v[20:23] offset:16
    s_mov_b64 exec, s[58:59]
    v_add_f32 v32, v16, v17
    v_add_f32 v33, v18, v19
    v_add_f32 v34, v20, v21
    v_add_f32 v35, v22, v23
    v_add_f32 v32, v32, v33
    v_add_f32 v34, v34, v35
    v_add_f32 v32, v32, v34
    s_nop 1
    v_add_f32_dpp v32, v32, v32 quad_perm:[1,0,3,2] row_mask:0xf bank_mask:0xf
    s_nop 1
    v_add_f32_dpp v32, v32, v32 quad_perm:[2,3,0,1] row_mask:0xf bank_mask:0xf
    s_nop 1
    v_add_f32_dpp v32, v32, v32 row_half_mirror row_mask:0xf bank_mask:0xf
    s_nop 1
    v_add_f32_dpp v32, v32, v32 row_mirror row_mask:0xf bank_mask:0xf
    v_mov_b32 v33, v32
    s_nop 1
    v_permlane16_swap_b32 v32, v33
    s_nop 1
    v_add_f32 v32, v32, v33
    v_mov_b32 v33, v32
    s_nop 1
    v_permlane32_swap_b32 v32, v33
    s_nop 1
    v_add_f32 v32, v32, v33
    v_mul_f32 v32, 0x3b124925, v32
    v_sub_f32 v34, v16, v32
    v_sub_f32 v35, v17, v32
    v_mul_f32 v33, v34, v34
    v_mul_f32 v35, v35, v35
    v_sub_f32 v34, v18, v32
    v_fmac_f32 v33, v34, v34
    v_sub_f32 v34, v19, v32
    v_fmac_f32 v35, v34, v34
    v_sub_f32 v34, v20, v32
    v_fmac_f32 v33, v34, v34
    v_sub_f32 v34, v21, v32
    v_fmac_f32 v35, v34, v34
    v_sub_f32 v34, v22, v32
    v_fmac_f32 v33, v34, v34
    v_sub_f32 v34, v23, v32
    v_fmac_f32 v35, v34, v34
    v_add_f32 v33, v33, v35
    v_cndmask_b32 v33, 0, v33, s[56:57]
    s_nop 1
    v_add_f32_dpp v33, v33, v33 quad_perm:[1,0,3,2] row_mask:0xf bank_mask:0xf
    s_nop 1
    v_add_f32_dpp v33, v33, v33 quad_perm:[2,3,0,1] row_mask:0xf bank_mask:0xf
    s_nop 1
    v_add_f32_dpp v33, v33, v33 row_half_mirror row_mask:0xf bank_mask:0xf
    s_nop 1
    v_add_f32_dpp v33, v33, v33 row_mirror row_mask:0xf bank_mask:0xf
    v_mov_b32 v34, v33
    s_nop 1
    v_permlane16_swap_b32 v33, v34
    s_nop 1
    v_add_f32 v33, v33, v34
    v_mov_b32 v34, v33
    s_nop 1
    v_permlane32_swap_b32 v33, v34
    s_nop 1
    v_add_f32 v33, v33, v34
    v_mul_f32 v33, 0x3b124925, v33
    v_cvt_pk_bf16_f32 v33, v33, v33
    v_and_b32 v33, 0xffff0000, v33
    v_add_f32 v33, 0x3727c5ac, v33
    v_cvt_pk_bf16_f32 v33, v33, v33
    v_and_b32 v33, 0xffff0000, v33
    v_sqrt_f32 v33, v33
    v_cvt_pk_bf16_f32 v32, v32, v32
    v_and_b32 v32, 0xffff0000, v32
    v_cvt_pk_bf16_f32 v33, v33, v33
    v_and_b32 v33, 0xffff0000, v33
    v_rcp_f32 v33, v33
    v_sub_f32 v16, v16, v32
    v_sub_f32 v17, v17, v32
    v_cvt_pk_bf16_f32 v34, v16, v17
    v_lshlrev_b32 v16, 16, v34
    v_and_b32 v17, 0xffff0000, v34
    v_sub_f32 v18, v18, v32
    v_sub_f32 v19, v19, v32
    v_cvt_pk_bf16_f32 v34, v18, v19
    v_lshlrev_b32 v18, 16, v34
    v_and_b32 v19, 0xffff0000, v34
    v_sub_f32 v20, v20, v32
    v_sub_f32 v21, v21, v32
    v_cvt_pk_bf16_f32 v34, v20, v21
    v_lshlrev_b32 v20, 16, v34
    v_and_b32 v21, 0xffff0000, v34
    v_sub_f32 v22, v22, v32
    v_sub_f32 v23, v23, v32
    v_cvt_pk_bf16_f32 v34, v22, v23
    v_lshlrev_b32 v22, 16, v34
    v_and_b32 v23, 0xffff0000, v34
    v_mul_f32 v16, v16, v33
    v_mul_f32 v17, v17, v33
    v_cvt_pk_bf16_f32 v34, v16, v17
    v_lshlrev_b32 v16, 16, v34
    v_and_b32 v17, 0xffff0000, v34
    v_mul_f32 v18, v18, v33
    v_mul_f32 v19, v19, v33
    v_cvt_pk_bf16_f32 v34, v18, v19
    v_lshlrev_b32 v18, 16, v34
    v_and_b32 v19, 0xffff0000, v34
    v_mul_f32 v20, v20, v33
    v_mul_f32 v21, v21, v33
    v_cvt_pk_bf16_f32 v34, v20, v21
    v_lshlrev_b32 v20, 16, v34
    v_and_b32 v21, 0xffff0000, v34
    v_mul_f32 v22, v22, v33
    v_mul_f32 v23, v23, v33
    v_cvt_pk_bf16_f32 v34, v22, v23
    v_lshlrev_b32 v22, 16, v34
    v_and_b32 v23, 0xffff0000, v34
    v_cndmask_b32 v16, 0, v16, s[56:57]
    v_cndmask_b32 v17, 0, v17, s[56:57]
    v_cndmask_b32 v18, 0, v18, s[56:57]
    v_cndmask_b32 v19, 0, v19, s[56:57]
    v_cndmask_b32 v20, 0, v20, s[56:57]
    v_cndmask_b32 v21, 0, v21, s[56:57]
    v_cndmask_b32 v22, 0, v22, s[56:57]
    v_cndmask_b32 v23, 0, v23, s[56:57]
    v_add_f32 v32, v16, v17
    v_add_f32 v33, v18, v19
    v_add_f32 v34, v20, v21
    v_add_f32 v35, v22, v23
    v_add_f32 v32, v32, v33
    v_add_f32 v34, v34, v35
    v_add_f32 v32, v32, v34
    s_nop 1
    v_add_f32_dpp v32, v32, v32 quad_perm:[1,0,3,2] row_mask:0xf bank_mask:0xf
    s_nop 1
    v_add_f32_dpp v32, v32, v32 quad_perm:[2,3,0,1] row_mask:0xf bank_mask:0xf
    s_nop 1
    v_add_f32_dpp v32, v32, v32 row_half_mirror row_mask:0xf bank_mask:0xf
    s_nop 1
    v_add_f32_dpp v32, v32, v32 row_mirror row_mask:0xf bank_mask:0xf
    v_mov_b32 v33, v32
    s_nop 1
    v_permlane16_swap_b32 v32, v33
    s_nop 1
    v_add_f32 v32, v32, v33
    v_mov_b32 v33, v32
    s_nop 1
    v_permlane32_swap_b32 v32, v33
    s_nop 1
    v_add_f32 v32, v32, v33
    v_mul_f32 v32, 0x3b124925, v32
    v_sub_f32 v34, v16, v32
    v_sub_f32 v35, v17, v32
    v_mul_f32 v33, v34, v34
    v_mul_f32 v35, v35, v35
    v_sub_f32 v34, v18, v32
    v_fmac_f32 v33, v34, v34
    v_sub_f32 v34, v19, v32
    v_fmac_f32 v35, v34, v34
    v_sub_f32 v34, v20, v32
    v_fmac_f32 v33, v34, v34
    v_sub_f32 v34, v21, v32
    v_fmac_f32 v35, v34, v34
    v_sub_f32 v34, v22, v32
    v_fmac_f32 v33, v34, v34
    v_sub_f32 v34, v23, v32
    v_fmac_f32 v35, v34, v34
    v_add_f32 v33, v33, v35
    v_cndmask_b32 v33, 0, v33, s[56:57]
    s_nop 1
    v_add_f32_dpp v33, v33, v33 quad_perm:[1,0,3,2] row_mask:0xf bank_mask:0xf
    s_nop 1
    v_add_f32_dpp v33, v33, v33 quad_perm:[2,3,0,1] row_mask:0xf bank_mask:0xf
    s_nop 1
    v_add_f32_dpp v33, v33, v33 row_half_mirror row_mask:0xf bank_mask:0xf
    s_nop 1
    v_add_f32_dpp v33, v33, v33 row_mirror row_mask:0xf bank_mask:0xf
    v_mov_b32 v34, v33
    s_nop 1
    v_permlane16_swap_b32 v33, v34
    s_nop 1
    v_add_f32 v33, v33, v34
    v_mov_b32 v34, v33
    s_nop 1
    v_permlane32_swap_b32 v33, v34
    s_nop 1
    v_add_f32 v33, v33, v34
    v_mul_f32 v33, 0x3b124925, v33
    v_cvt_pk_bf16_f32 v33, v33, v33
    v_and_b32 v33, 0xffff0000, v33
    v_add_f32 v33, 0x3727c5ac, v33
    v_cvt_pk_bf16_f32 v33, v33, v33
    v_and_b32 v33, 0xffff0000, v33
    v_sqrt_f32 v33, v33
    v_cvt_pk_bf16_f32 v32, v32, v32
    v_and_b32 v32, 0xffff0000, v32
    v_cvt_pk_bf16_f32 v33, v33, v33
    v_and_b32 v33, 0xffff0000, v33
    v_rcp_f32 v33, v33
    v_sub_f32 v16, v16, v32
    v_sub_f32 v17, v17, v32
    v_cvt_pk_bf16_f32 v34, v16, v17
    v_lshlrev_b32 v16, 16, v34
    v_and_b32 v17, 0xffff0000, v34
    v_sub_f32 v18, v18, v32
    v_sub_f32 v19, v19, v32
    v_cvt_pk_bf16_f32 v34, v18, v19
    v_lshlrev_b32 v18, 16, v34
    v_and_b32 v19, 0xffff0000, v34
    v_sub_f32 v20, v20, v32
    v_sub_f32 v21, v21, v32
    v_cvt_pk_bf16_f32 v34, v20, v21
    v_lshlrev_b32 v20, 16, v34
    v_and_b32 v21, 0xffff0000, v34
    v_sub_f32 v22, v22, v32
    v_sub_f32 v23, v23, v32
    v_cvt_pk_bf16_f32 v34, v22, v23
    v_lshlrev_b32 v22, 16, v34
    v_and_b32 v23, 0xffff0000, v34
    v_mul_f32 v16, v16, v33
    v_mul_f32 v17, v17, v33
    v_cvt_pk_bf16_f32 v34, v16, v17
    v_lshlrev_b32 v16, 16, v34
    v_and_b32 v17, 0xffff0000, v34
    v_mul_f32 v18, v18, v33
    v_mul_f32 v19, v19, v33
    v_cvt_pk_bf16_f32 v34, v18, v19
    v_lshlrev_b32 v18, 16, v34
    v_and_b32 v19, 0xffff0000, v34
    v_mul_f32 v20, v20, v33
    v_mul_f32 v21, v21, v33
    v_cvt_pk_bf16_f32 v34, v20, v21
    v_lshlrev_b32 v20, 16, v34
    v_and_b32 v21, 0xffff0000, v34
    v_mul_f32 v22, v22, v33
    v_mul_f32 v23, v23, v33
    v_cvt_pk_bf16_f32 v34, v22, v23
    v_lshlrev_b32 v22, 16, v34
    v_and_b32 v23, 0xffff0000, v34
    s_mov_b64 exec, s[56:57]
    ds_write_b128 v5, v[16:19] offset:2048
    ds_write_b128 v5, v[20:23] offset:2064
    s_mov_b64 exec, s[58:59]
    s_waitcnt lgkmcnt(0)
    s_barrier
    s_branch L_done
L_bar5:
    s_waitcnt vmcnt(0)
    v_lshlrev_b32 v16, 16, v128
    v_and_b32 v17, 0xffff0000, v128
    v_lshlrev_b32 v44, 16, v144
    v_and_b32 v45, 0xffff0000, v144
    v_lshlrev_b32 v18, 16, v129
    v_and_b32 v19, 0xffff0000, v129
    v_lshlrev_b32 v46, 16, v145
    v_and_b32 v47, 0xffff0000, v145
    v_lshlrev_b32 v20, 16, v130
    v_and_b32 v21, 0xffff0000, v130
    v_lshlrev_b32 v48, 16, v146
    v_and_b32 v49, 0xffff0000, v146
    v_lshlrev_b32 v22, 16, v131
    v_and_b32 v23, 0xffff0000, v131
    v_lshlrev_b32 v50, 16, v147
    v_and_b32 v51, 0xffff0000, v147
    v_lshlrev_b32 v24, 16, v132
    v_and_b32 v25, 0xffff0000, v132
    v_lshlrev_b32 v52, 16, v148
    v_and_b32 v53, 0xffff0000, v148
    v_lshlrev_b32 v26, 16, v133
    v_and_b32 v27, 0xffff0000, v133
    v_lshlrev_b32 v54, 16, v149
    v_and_b32 v55, 0xffff0000, v149
    v_lshlrev_b32 v28, 16, v134
    v_and_b32 v29, 0xffff0000, v134
    v_lshlrev_b32 v56, 16, v150
    v_and_b32 v57, 0xffff0000, v150
    v_lshlrev_b32 v30, 16, v135
    v_and_b32 v31, 0xffff0000, v135
    v_lshlrev_b32 v58, 16, v151
    v_and_b32 v59, 0xffff0000, v151
    v_lshlrev_b32 v32, 16, v136
    v_and_b32 v33, 0xffff0000, v136
    v_lshlrev_b32 v60, 16, v152
    v_and_b32 v61, 0xffff0000, v152
    v_lshlrev_b32 v34, 16, v137
    v_and_b32 v35, 0xffff0000, v137
    v_lshlrev_b32 v62, 16, v153
    v_and_b32 v63, 0xffff0000, v153
    v_lshlrev_b32 v36, 16, v138
    v_and_b32 v37, 0xffff0000, v138
    v_lshlrev_b32 v64, 16, v154
    v_and_b32 v65, 0xffff0000, v154
    v_lshlrev_b32 v38, 16, v139
    v_and_b32 v39, 0xffff0000, v139
    v_lshlrev_b32 v66, 16, v155
    v_and_b32 v67, 0xffff0000, v155
    v_lshlrev_b32 v40, 16, v140
    v_and_b32 v41, 0xffff0000, v140
    v_lshlrev_b32 v68, 16, v156
    v_and_b32 v69, 0xffff0000, v156
    v_lshlrev_b32 v42, 16, v141
    v_and_b32 v43, 0xffff0000, v141
    v_lshlrev_b32 v70, 16, v157
    v_and_b32 v71, 0xffff0000, v157
    v_lshlrev_b32 v174, 16, v174
    v_mov_b32 v72, 0xc0135761
    v_mov_b32 v73, 0xc0135761
    v_mov_b32 v74, 0xbdd2d3e8
    v_mov_b32 v75, 0xbdd2d3e8
    v_mov_b32 v76, 1.0
    v_mov_b32 v77, 1.0
    v_mov_b32 v78, 0
    v_mov_b32 v79, 0
    s_mul_i32 s6, s97, 56
    s_lshl_b32 s7, s3, 3
    s_add_u32 s6, s6, s7
    s_add_u32 s6, s6, 157696
    v_mov_b32 v5, s6
    s_barrier
    ds_read_b64 v[80:81], v5 offset:2048
    ds_read_b64 v[82:83], v5
    s_waitcnt lgkmcnt(0)
    v_pk_mul_f32 v[84:85], v[80:81], v[16:17] op_sel_hi:[0,1]
    v_pk_mul_f32 v[92:93], v[80:81], v[16:17] op_sel:[1,0] op_sel_hi:[1,1]
    v_cvt_pk_bf16_f32 v88, v84, v85
    v_lshlrev_b32 v84, 16, v88
    v_and_b32 v85, 0xffff0000, v88
    v_cvt_pk_bf16_f32 v96, v92, v93
    v_lshlrev_b32 v92, 16, v96
    v_and_b32 v93, 0xffff0000, v96
    v_pk_add_f32 v[84:85], v[84:85], v[44:45]
    v_pk_add_f32 v[92:93], v[92:93], v[44:45]
    v_cvt_pk_bf16_f32 v88, v84, v85
    v_lshlrev_b32 v84, 16, v88
    v_and_b32 v85, 0xffff0000, v88
    v_cvt_pk_bf16_f32 v96, v92, v93
    v_lshlrev_b32 v92, 16, v96
    v_and_b32 v93, 0xffff0000, v96
    v_pk_mul_f32 v[86:87], v[84:85], v[84:85]
    v_pk_mul_f32 v[94:95], v[92:93], v[92:93]
    v_pk_fma_f32 v[86:87], v[86:87], v[74:75], v[72:73]
    v_pk_fma_f32 v[94:95], v[94:95], v[74:75], v[72:73]
    v_pk_mul_f32 v[86:87], v[86:87], v[84:85]
    v_pk_mul_f32 v[94:95], v[94:95], v[92:93]
    v_exp_f32 v86, v86
    v_exp_f32 v87, v87
    v_exp_f32 v94, v94
    v_exp_f32 v95, v95
    v_pk_add_f32 v[86:87], v[86:87], v[76:77]
    v_pk_add_f32 v[94:95], v[94:95], v[76:77]
    v_rcp_f32 v86, v86
    v_rcp_f32 v87, v87
    v_rcp_f32 v94, v94
    v_rcp_f32 v95, v95
    v_pk_mul_f32 v[86:87], v[86:87], v[84:85]
    v_pk_mul_f32 v[94:95], v[94:95], v[92:93]
    v_cvt_pk_bf16_f32 v88, v86, v87
    v_cvt_pk_bf16_f32 v96, v94, v95
    v_dot2_f32_bf16 v78, v88, v160, v78
    v_dot2_f32_bf16 v79, v96, v160, v79
    v_pk_mul_f32 v[84:85], v[80:81], v[18:19] op_sel_hi:[0,1]
    v_pk_mul_f32 v[92:93], v[80:81], v[18:19] op_sel:[1,0] op_sel_hi:[1,1]
    v_cvt_pk_bf16_f32 v88, v84, v85
    v_lshlrev_b32 v84, 16, v88
    v_and_b32 v85, 0xffff0000, v88
    v_cvt_pk_bf16_f32 v96, v92, v93
    v_lshlrev_b32 v92, 16, v96
    v_and_b32 v93, 0xffff0000, v96
    v_pk_add_f32 v[84:85], v[84:85], v[46:47]
    v_pk_add_f32 v[92:93], v[92:93], v[46:47]
    v_cvt_pk_bf16_f32 v88, v84, v85
    v_lshlrev_b32 v84, 16, v88
    v_and_b32 v85, 0xffff0000, v88
    v_cvt_pk_bf16_f32 v96, v92, v93
    v_lshlrev_b32 v92, 16, v96
    v_and_b32 v93, 0xffff0000, v96
    v_pk_mul_f32 v[86:87], v[84:85], v[84:85]
    v_pk_mul_f32 v[94:95], v[92:93], v[92:93]
    v_pk_fma_f32 v[86:87], v[86:87], v[74:75], v[72:73]
    v_pk_fma_f32 v[94:95], v[94:95], v[74:75], v[72:73]
    v_pk_mul_f32 v[86:87], v[86:87], v[84:85]
    v_pk_mul_f32 v[94:95], v[94:95], v[92:93]
    v_exp_f32 v86, v86
    v_exp_f32 v87, v87
    v_exp_f32 v94, v94
    v_exp_f32 v95, v95
    v_pk_add_f32 v[86:87], v[86:87], v[76:77]
    v_pk_add_f32 v[94:95], v[94:95], v[76:77]
    v_rcp_f32 v86, v86
    v_rcp_f32 v87, v87
    v_rcp_f32 v94, v94
    v_rcp_f32 v95, v95
    v_pk_mul_f32 v[86:87], v[86:87], v[84:85]
    v_pk_mul_f32 v[94:95], v[94:95], v[92:93]
    v_cvt_pk_bf16_f32 v88, v86, v87
    v_cvt_pk_bf16_f32 v96, v94, v95
    v_dot2_f32_bf16 v78, v88, v161, v78
    v_dot2_f32_bf16 v79, v96, v161, v79
    v_pk_mul_f32 v[84:85], v[80:81], v[20:21] op_sel_hi:[0,1]
    v_pk_mul_f32 v[92:93], v[80:81], v[20:21] op_sel:[1,0] op_sel_hi:[1,1]
    v_cvt_pk_bf16_f32 v88, v84, v85
    v_lshlrev_b32 v84, 16, v88
    v_and_b32 v85, 0xffff0000, v88
    v_cvt_pk_bf16_f32 v96, v92, v93
    v_lshlrev_b32 v92, 16, v96
    v_and_b32 v93, 0xffff0000, v96
    v_pk_add_f32 v[84:85], v[84:85], v[48:49]
    v_pk_add_f32 v[92:93], v[92:93], v[48:49]
    v_cvt_pk_bf16_f32 v88, v84, v85
    v_lshlrev_b32 v84, 16, v88
    v_and_b32 v85, 0xffff0000, v88
    v_cvt_pk_bf16_f32 v96, v92, v93
    v_lshlrev_b32 v92, 16, v96
    v_and_b32 v93, 0xffff0000, v96
    v_pk_mul_f32 v[86:87], v[84:85], v[84:85]
    v_pk_mul_f32 v[94:95], v[92:93], v[92:93]
    v_pk_fma_f32 v[86:87], v[86:87], v[74:75], v[72:73]
    v_pk_fma_f32 v[94:95], v[94:95], v[74:75], v[72:73]
    v_pk_mul_f32 v[86:87], v[86:87], v[84:85]
    v_pk_mul_f32 v[94:95], v[94:95], v[92:93]
    v_exp_f32 v86, v86
    v_exp_f32 v87, v87
    v_exp_f32 v94, v94
    v_exp_f32 v95, v95
    v_pk_add_f32 v[86:87], v[86:87], v[76:77]
    v_pk_add_f32 v[94:95], v[94:95], v[76:77]
    v_rcp_f32 v86, v86
    v_rcp_f32 v87, v87
    v_rcp_f32 v94, v94
    v_rcp_f32 v95, v95
    v_pk_mul_f32 v[86:87], v[86:87], v[84:85]
    v_pk_mul_f32 v[94:95], v[94:95], v[92:93]
    v_cvt_pk_bf16_f32 v88, v86, v87
    v_cvt_pk_bf16_f32 v96, v94, v95
    v_dot2_f32_bf16 v78, v88, v162, v78
    v_dot2_f32_bf16 v79, v96, v162, v79
    v_pk_mul_f32 v[84:85], v[80:81], v[22:23] op_sel_hi:[0,1]
    v_pk_mul_f32 v[92:93], v[80:81], v[22:23] op_sel:[1,0] op_sel_hi:[1,1]
    v_cvt_pk_bf16_f32 v88, v84, v85
    v_lshlrev_b32 v84, 16, v88
    v_and_b32 v85, 0xffff0000, v88
    v_cvt_pk_bf16_f32 v96, v92, v93
    v_lshlrev_b32 v92, 16, v96
    v_and_b32 v93, 0xffff0000, v96
    v_pk_add_f32 v[84:85], v[84:85], v[50:51]
    v_pk_add_f32 v[92:93], v[92:93], v[50:51]
    v_cvt_pk_bf16_f32 v88, v84, v85
    v_lshlrev_b32 v84, 16, v88
    v_and_b32 v85, 0xffff0000, v88
    v_cvt_pk_bf16_f32 v96, v92, v93
    v_lshlrev_b32 v92, 16, v96
    v_and_b32 v93, 0xffff0000, v96
    v_pk_mul_f32 v[86:87], v[84:85], v[84:85]
    v_pk_mul_f32 v[94:95], v[92:93], v[92:93]
    v_pk_fma_f32 v[86:87], v[86:87], v[74:75], v[72:73]
    v_pk_fma_f32 v[94:95], v[94:95], v[74:75], v[72:73]
    v_pk_mul_f32 v[86:87], v[86:87], v[84:85]
    v_pk_mul_f32 v[94:95], v[94:95], v[92:93]
    v_exp_f32 v86, v86
    v_exp_f32 v87, v87
    v_exp_f32 v94, v94
    v_exp_f32 v95, v95
    v_pk_add_f32 v[86:87], v[86:87], v[76:77]
    v_pk_add_f32 v[94:95], v[94:95], v[76:77]
    v_rcp_f32 v86, v86
    v_rcp_f32 v87, v87
    v_rcp_f32 v94, v94
    v_rcp_f32 v95, v95
    v_pk_mul_f32 v[86:87], v[86:87], v[84:85]
    v_pk_mul_f32 v[94:95], v[94:95], v[92:93]
    v_cvt_pk_bf16_f32 v88, v86, v87
    v_cvt_pk_bf16_f32 v96, v94, v95
    v_dot2_f32_bf16 v78, v88, v163, v78
    v_dot2_f32_bf16 v79, v96, v163, v79
    v_pk_mul_f32 v[84:85], v[80:81], v[24:25] op_sel_hi:[0,1]
    v_pk_mul_f32 v[92:93], v[80:81], v[24:25] op_sel:[1,0] op_sel_hi:[1,1]
    v_cvt_pk_bf16_f32 v88, v84, v85
    v_lshlrev_b32 v84, 16, v88
    v_and_b32 v85, 0xffff0000, v88
    v_cvt_pk_bf16_f32 v96, v92, v93
    v_lshlrev_b32 v92, 16, v96
    v_and_b32 v93, 0xffff0000, v96
    v_pk_add_f32 v[84:85], v[84:85], v[52:53]
    v_pk_add_f32 v[92:93], v[92:93], v[52:53]
    v_cvt_pk_bf16_f32 v88, v84, v85
    v_lshlrev_b32 v84, 16, v88
    v_and_b32 v85, 0xffff0000, v88
    v_cvt_pk_bf16_f32 v96, v92, v93
    v_lshlrev_b32 v92, 16, v96
    v_and_b32 v93, 0xffff0000, v96
    v_pk_mul_f32 v[86:87], v[84:85], v[84:85]
    v_pk_mul_f32 v[94:95], v[92:93], v[92:93]
    v_pk_fma_f32 v[86:87], v[86:87], v[74:75], v[72:73]
    v_pk_fma_f32 v[94:95], v[94:95], v[74:75], v[72:73]
    v_pk_mul_f32 v[86:87], v[86:87], v[84:85]
    v_pk_mul_f32 v[94:95], v[94:95], v[92:93]
    v_exp_f32 v86, v86
    v_exp_f32 v87, v87
    v_exp_f32 v94, v94
    v_exp_f32 v95, v95
    v_pk_add_f32 v[86:87], v[86:87], v[76:77]
    v_pk_add_f32 v[94:95], v[94:95], v[76:77]
    v_rcp_f32 v86, v86
    v_rcp_f32 v87, v87
    v_rcp_f32 v94, v94
    v_rcp_f32 v95, v95
    v_pk_mul_f32 v[86:87], v[86:87], v[84:85]
    v_pk_mul_f32 v[94:95], v[94:95], v[92:93]
    v_cvt_pk_bf16_f32 v88, v86, v87
    v_cvt_pk_bf16_f32 v96, v94, v95
    v_dot2_f32_bf16 v78, v88, v164, v78
    v_dot2_f32_bf16 v79, v96, v164, v79
    v_pk_mul_f32 v[84:85], v[80:81], v[26:27] op_sel_hi:[0,1]
    v_pk_mul_f32 v[92:93], v[80:81], v[26:27] op_sel:[1,0] op_sel_hi:[1,1]
    v_cvt_pk_bf16_f32 v88, v84, v85
    v_lshlrev_b32 v84, 16, v88
    v_and_b32 v85, 0xffff0000, v88
    v_cvt_pk_bf16_f32 v96, v92, v93
    v_lshlrev_b32 v92, 16, v96
    v_and_b32 v93, 0xffff0000, v96
    v_pk_add_f32 v[84:85], v[84:85], v[54:55]
    v_pk_add_f32 v[92:93], v[92:93], v[54:55]
    v_cvt_pk_bf16_f32 v88, v84, v85
    v_lshlrev_b32 v84, 16, v88
    v_and_b32 v85, 0xffff0000, v88
    v_cvt_pk_bf16_f32 v96, v92, v93
    v_lshlrev_b32 v92, 16, v96
    v_and_b32 v93, 0xffff0000, v96
    v_pk_mul_f32 v[86:87], v[84:85], v[84:85]
    v_pk_mul_f32 v[94:95], v[92:93], v[92:93]
    v_pk_fma_f32 v[86:87], v[86:87], v[74:75], v[72:73]
    v_pk_fma_f32 v[94:95], v[94:95], v[74:75], v[72:73]
    v_pk_mul_f32 v[86:87], v[86:87], v[84:85]
    v_pk_mul_f32 v[94:95], v[94:95], v[92:93]
    v_exp_f32 v86, v86
    v_exp_f32 v87, v87
    v_exp_f32 v94, v94
    v_exp_f32 v95, v95
    v_pk_add_f32 v[86:87], v[86:87], v[76:77]
    v_pk_add_f32 v[94:95], v[94:95], v[76:77]
    v_rcp_f32 v86, v86
    v_rcp_f32 v87, v87
    v_rcp_f32 v94, v94
    v_rcp_f32 v95, v95
    v_pk_mul_f32 v[86:87], v[86:87], v[84:85]
    v_pk_mul_f32 v[94:95], v[94:95], v[92:93]
    v_cvt_pk_bf16_f32 v88, v86, v87
    v_cvt_pk_bf16_f32 v96, v94, v95
    v_dot2_f32_bf16 v78, v88, v165, v78
    v_dot2_f32_bf16 v79, v96, v165, v79
    v_pk_mul_f32 v[84:85], v[80:81], v[28:29] op_sel_hi:[0,1]
    v_pk_mul_f32 v[92:93], v[80:81], v[28:29] op_sel:[1,0] op_sel_hi:[1,1]
    v_cvt_pk_bf16_f32 v88, v84, v85
    v_lshlrev_b32 v84, 16, v88
    v_and_b32 v85, 0xffff0000, v88
    v_cvt_pk_bf16_f32 v96, v92, v93
    v_lshlrev_b32 v92, 16, v96
    v_and_b32 v93, 0xffff0000, v96
    v_pk_add_f32 v[84:85], v[84:85], v[56:57]
    v_pk_add_f32 v[92:93], v[92:93], v[56:57]
    v_cvt_pk_bf16_f32 v88, v84, v85
    v_lshlrev_b32 v84, 16, v88
    v_and_b32 v85, 0xffff0000, v88
    v_cvt_pk_bf16_f32 v96, v92, v93
    v_lshlrev_b32 v92, 16, v96
    v_and_b32 v93, 0xffff0000, v96
    v_pk_mul_f32 v[86:87], v[84:85], v[84:85]
    v_pk_mul_f32 v[94:95], v[92:93], v[92:93]
    v_pk_fma_f32 v[86:87], v[86:87], v[74:75], v[72:73]
    v_pk_fma_f32 v[94:95], v[94:95], v[74:75], v[72:73]
    v_pk_mul_f32 v[86:87], v[86:87], v[84:85]
    v_pk_mul_f32 v[94:95], v[94:95], v[92:93]
    v_exp_f32 v86, v86
    v_exp_f32 v87, v87
    v_exp_f32 v94, v94
    v_exp_f32 v95, v95
    v_pk_add_f32 v[86:87], v[86:87], v[76:77]
    v_pk_add_f32 v[94:95], v[94:95], v[76:77]
    v_rcp_f32 v86, v86
    v_rcp_f32 v87, v87
    v_rcp_f32 v94, v94
    v_rcp_f32 v95, v95
    v_pk_mul_f32 v[86:87], v[86:87], v[84:85]
    v_pk_mul_f32 v[94:95], v[94:95], v[92:93]
    v_cvt_pk_bf16_f32 v88, v86, v87
    v_cvt_pk_bf16_f32 v96, v94, v95
    v_dot2_f32_bf16 v78, v88, v166, v78
    v_dot2_f32_bf16 v79, v96, v166, v79
    v_pk_mul_f32 v[84:85], v[80:81], v[30:31] op_sel_hi:[0,1]
    v_pk_mul_f32 v[92:93], v[80:81], v[30:31] op_sel:[1,0] op_sel_hi:[1,1]
    v_cvt_pk_bf16_f32 v88, v84, v85
    v_lshlrev_b32 v84, 16, v88
    v_and_b32 v85, 0xffff0000, v88
    v_cvt_pk_bf16_f32 v96, v92, v93
    v_lshlrev_b32 v92, 16, v96
    v_and_b32 v93, 0xffff0000, v96
    v_pk_add_f32 v[84:85], v[84:85], v[58:59]
    v_pk_add_f32 v[92:93], v[92:93], v[58:59]
    v_cvt_pk_bf16_f32 v88, v84, v85
    v_lshlrev_b32 v84, 16, v88
    v_and_b32 v85, 0xffff0000, v88
    v_cvt_pk_bf16_f32 v96, v92, v93
    v_lshlrev_b32 v92, 16, v96
    v_and_b32 v93, 0xffff0000, v96
    v_pk_mul_f32 v[86:87], v[84:85], v[84:85]
    v_pk_mul_f32 v[94:95], v[92:93], v[92:93]
    v_pk_fma_f32 v[86:87], v[86:87], v[74:75], v[72:73]
    v_pk_fma_f32 v[94:95], v[94:95], v[74:75], v[72:73]
    v_pk_mul_f32 v[86:87], v[86:87], v[84:85]
    v_pk_mul_f32 v[94:95], v[94:95], v[92:93]
    v_exp_f32 v86, v86
    v_exp_f32 v87, v87
    v_exp_f32 v94, v94
    v_exp_f32 v95, v95
    v_pk_add_f32 v[86:87], v[86:87], v[76:77]
    v_pk_add_f32 v[94:95], v[94:95], v[76:77]
    v_rcp_f32 v86, v86
    v_rcp_f32 v87, v87
    v_rcp_f32 v94, v94
    v_rcp_f32 v95, v95
    v_pk_mul_f32 v[86:87], v[86:87], v[84:85]
    v_pk_mul_f32 v[94:95], v[94:95], v[92:93]
    v_cvt_pk_bf16_f32 v88, v86, v87
    v_cvt_pk_bf16_f32 v96, v94, v95
    v_dot2_f32_bf16 v78, v88, v167, v78
    v_dot2_f32_bf16 v79, v96, v167, v79
    v_pk_mul_f32 v[84:85], v[80:81], v[32:33] op_sel_hi:[0,1]
    v_pk_mul_f32 v[92:93], v[80:81], v[32:33] op_sel:[1,0] op_sel_hi:[1,1]
    v_cvt_pk_bf16_f32 v88, v84, v85
    v_lshlrev_b32 v84, 16, v88
    v_and_b32 v85, 0xffff0000, v88
    v_cvt_pk_bf16_f32 v96, v92, v93
    v_lshlrev_b32 v92, 16, v96
    v_and_b32 v93, 0xffff0000, v96
    v_pk_add_f32 v[84:85], v[84:85], v[60:61]
    v_pk_add_f32 v[92:93], v[92:93], v[60:61]
    v_cvt_pk_bf16_f32 v88, v84, v85
    v_lshlrev_b32 v84, 16, v88
    v_and_b32 v85, 0xffff0000, v88
    v_cvt_pk_bf16_f32 v96, v92, v93
    v_lshlrev_b32 v92, 16, v96
    v_and_b32 v93, 0xffff0000, v96
    v_pk_mul_f32 v[86:87], v[84:85], v[84:85]
    v_pk_mul_f32 v[94:95], v[92:93], v[92:93]
    v_pk_fma_f32 v[86:87], v[86:87], v[74:75], v[72:73]
    v_pk_fma_f32 v[94:95], v[94:95], v[74:75], v[72:73]
    v_pk_mul_f32 v[86:87], v[86:87], v[84:85]
    v_pk_mul_f32 v[94:95], v[94:95], v[92:93]
    v_exp_f32 v86, v86
    v_exp_f32 v87, v87
    v_exp_f32 v94, v94
    v_exp_f32 v95, v95
    v_pk_add_f32 v[86:87], v[86:87], v[76:77]
    v_pk_add_f32 v[94:95], v[94:95], v[76:77]
    v_rcp_f32 v86, v86
    v_rcp_f32 v87, v87
    v_rcp_f32 v94, v94
    v_rcp_f32 v95, v95
    v_pk_mul_f32 v[86:87], v[86:87], v[84:85]
    v_pk_mul_f32 v[94:95], v[94:95], v[92:93]
    v_cvt_pk_bf16_f32 v88, v86, v87
    v_cvt_pk_bf16_f32 v96, v94, v95
    v_dot2_f32_bf16 v78, v88, v168, v78
    v_dot2_f32_bf16 v79, v96, v168, v79
    v_pk_mul_f32 v[84:85], v[80:81], v[34:35] op_sel_hi:[0,1]
    v_pk_mul_f32 v[92:93], v[80:81], v[34:35] op_sel:[1,0] op_sel_hi:[1,1]
    v_cvt_pk_bf16_f32 v88, v84, v85
    v_lshlrev_b32 v84, 16, v88
    v_and_b32 v85, 0xffff0000, v88
    v_cvt_pk_bf16_f32 v96, v92, v93
    v_lshlrev_b32 v92, 16, v96
    v_and_b32 v93, 0xffff0000, v96
    v_pk_add_f32 v[84:85], v[84:85], v[62:63]
    v_pk_add_f32 v[92:93], v[92:93], v[62:63]
    v_cvt_pk_bf16_f32 v88, v84, v85
    v_lshlrev_b32 v84, 16, v88
    v_and_b32 v85, 0xffff0000, v88
    v_cvt_pk_bf16_f32 v96, v92, v93
    v_lshlrev_b32 v92, 16, v96
    v_and_b32 v93, 0xffff0000, v96
    v_pk_mul_f32 v[86:87], v[84:85], v[84:85]
    v_pk_mul_f32 v[94:95], v[92:93], v[92:93]
    v_pk_fma_f32 v[86:87], v[86:87], v[74:75], v[72:73]
    v_pk_fma_f32 v[94:95], v[94:95], v[74:75], v[72:73]
    v_pk_mul_f32 v[86:87], v[86:87], v[84:85]
    v_pk_mul_f32 v[94:95], v[94:95], v[92:93]
    v_exp_f32 v86, v86
    v_exp_f32 v87, v87
    v_exp_f32 v94, v94
    v_exp_f32 v95, v95
    v_pk_add_f32 v[86:87], v[86:87], v[76:77]
    v_pk_add_f32 v[94:95], v[94:95], v[76:77]
    v_rcp_f32 v86, v86
    v_rcp_f32 v87, v87
    v_rcp_f32 v94, v94
    v_rcp_f32 v95, v95
    v_pk_mul_f32 v[86:87], v[86:87], v[84:85]
    v_pk_mul_f32 v[94:95], v[94:95], v[92:93]
    v_cvt_pk_bf16_f32 v88, v86, v87
    v_cvt_pk_bf16_f32 v96, v94, v95
    v_dot2_f32_bf16 v78, v88, v169, v78
    v_dot2_f32_bf16 v79, v96, v169, v79
    v_pk_mul_f32 v[84:85], v[80:81], v[36:37] op_sel_hi:[0,1]
    v_pk_mul_f32 v[92:93], v[80:81], v[36:37] op_sel:[1,0] op_sel_hi:[1,1]
    v_cvt_pk_bf16_f32 v88, v84, v85
    v_lshlrev_b32 v84, 16, v88
    v_and_b32 v85, 0xffff0000, v88
    v_cvt_pk_bf16_f32 v96, v92, v93
    v_lshlrev_b32 v92, 16, v96
    v_and_b32 v93, 0xffff0000, v96
    v_pk_add_f32 v[84:85], v[84:85], v[64:65]
    v_pk_add_f32 v[92:93], v[92:93], v[64:65]
    v_cvt_pk_bf16_f32 v88, v84, v85
    v_lshlrev_b32 v84, 16, v88
    v_and_b32 v85, 0xffff0000, v88
    v_cvt_pk_bf16_f32 v96, v92, v93
    v_lshlrev_b32 v92, 16, v96
    v_and_b32 v93, 0xffff0000, v96
    v_pk_mul_f32 v[86:87], v[84:85], v[84:85]
    v_pk_mul_f32 v[94:95], v[92:93], v[92:93]
    v_pk_fma_f32 v[86:87], v[86:87], v[74:75], v[72:73]
    v_pk_fma_f32 v[94:95], v[94:95], v[74:75], v[72:73]
    v_pk_mul_f32 v[86:87], v[86:87], v[84:85]
    v_pk_mul_f32 v[94:95], v[94:95], v[92:93]
    v_exp_f32 v86, v86
    v_exp_f32 v87, v87
    v_exp_f32 v94, v94
    v_exp_f32 v95, v95
    v_pk_add_f32 v[86:87], v[86:87], v[76:77]
    v_pk_add_f32 v[94:95], v[94:95], v[76:77]
    v_rcp_f32 v86, v86
    v_rcp_f32 v87, v87
    v_rcp_f32 v94, v94
    v_rcp_f32 v95, v95
    v_pk_mul_f32 v[86:87], v[86:87], v[84:85]
    v_pk_mul_f32 v[94:95], v[94:95], v[92:93]
    v_cvt_pk_bf16_f32 v88, v86, v87
    v_cvt_pk_bf16_f32 v96, v94, v95
    v_dot2_f32_bf16 v78, v88, v170, v78
    v_dot2_f32_bf16 v79, v96, v170, v79
    v_pk_mul_f32 v[84:85], v[80:81], v[38:39] op_sel_hi:[0,1]
    v_pk_mul_f32 v[92:93], v[80:81], v[38:39] op_sel:[1,0] op_sel_hi:[1,1]
    v_cvt_pk_bf16_f32 v88, v84, v85
    v_lshlrev_b32 v84, 16, v88
    v_and_b32 v85, 0xffff0000, v88
    v_cvt_pk_bf16_f32 v96, v92, v93
    v_lshlrev_b32 v92, 16, v96
    v_and_b32 v93, 0xffff0000, v96
    v_pk_add_f32 v[84:85], v[84:85], v[66:67]
    v_pk_add_f32 v[92:93], v[92:93], v[66:67]
    v_cvt_pk_bf16_f32 v88, v84, v85
    v_lshlrev_b32 v84, 16, v88
    v_and_b32 v85, 0xffff0000, v88
    v_cvt_pk_bf16_f32 v96, v92, v93
    v_lshlrev_b32 v92, 16, v96
    v_and_b32 v93, 0xffff0000, v96
    v_pk_mul_f32 v[86:87], v[84:85], v[84:85]
    v_pk_mul_f32 v[94:95], v[92:93], v[92:93]
    v_pk_fma_f32 v[86:87], v[86:87], v[74:75], v[72:73]
    v_pk_fma_f32 v[94:95], v[94:95], v[74:75], v[72:73]
    v_pk_mul_f32 v[86:87], v[86:87], v[84:85]
    v_pk_mul_f32 v[94:95], v[94:95], v[92:93]
    v_exp_f32 v86, v86
    v_exp_f32 v87, v87
    v_exp_f32 v94, v94
    v_exp_f32 v95, v95
    v_pk_add_f32 v[86:87], v[86:87], v[76:77]
    v_pk_add_f32 v[94:95], v[94:95], v[76:77]
    v_rcp_f32 v86, v86
    v_rcp_f32 v87, v87
    v_rcp_f32 v94, v94
    v_rcp_f32 v95, v95
    v_pk_mul_f32 v[86:87], v[86:87], v[84:85]
    v_pk_mul_f32 v[94:95], v[94:95], v[92:93]
    v_cvt_pk_bf16_f32 v88, v86, v87
    v_cvt_pk_bf16_f32 v96, v94, v95
    v_dot2_f32_bf16 v78, v88, v171, v78
    v_dot2_f32_bf16 v79, v96, v171, v79
    v_pk_mul_f32 v[84:85], v[80:81], v[40:41] op_sel_hi:[0,1]
    v_pk_mul_f32 v[92:93], v[80:81], v[40:41] op_sel:[1,0] op_sel_hi:[1,1]
    v_cvt_pk_bf16_f32 v88, v84, v85
    v_lshlrev_b32 v84, 16, v88
    v_and_b32 v85, 0xffff0000, v88
    v_cvt_pk_bf16_f32 v96, v92, v93
    v_lshlrev_b32 v92, 16, v96
    v_and_b32 v93, 0xffff0000, v96
    v_pk_add_f32 v[84:85], v[84:85], v[68:69]
    v_pk_add_f32 v[92:93], v[92:93], v[68:69]
    v_cvt_pk_bf16_f32 v88, v84, v85
    v_lshlrev_b32 v84, 16, v88
    v_and_b32 v85, 0xffff0000, v88
    v_cvt_pk_bf16_f32 v96, v92, v93
    v_lshlrev_b32 v92, 16, v96
    v_and_b32 v93, 0xffff0000, v96
    v_pk_mul_f32 v[86:87], v[84:85], v[84:85]
    v_pk_mul_f32 v[94:95], v[92:93], v[92:93]
    v_pk_fma_f32 v[86:87], v[86:87], v[74:75], v[72:73]
    v_pk_fma_f32 v[94:95], v[94:95], v[74:75], v[72:73]
    v_pk_mul_f32 v[86:87], v[86:87], v[84:85]
    v_pk_mul_f32 v[94:95], v[94:95], v[92:93]
    v_exp_f32 v86, v86
    v_exp_f32 v87, v87
    v_exp_f32 v94, v94
    v_exp_f32 v95, v95
    v_pk_add_f32 v[86:87], v[86:87], v[76:77]
    v_pk_add_f32 v[94:95], v[94:95], v[76:77]
    v_rcp_f32 v86, v86
    v_rcp_f32 v87, v87
    v_rcp_f32 v94, v94
    v_rcp_f32 v95, v95
    v_pk_mul_f32 v[86:87], v[86:87], v[84:85]
    v_pk_mul_f32 v[94:95], v[94:95], v[92:93]
    v_cvt_pk_bf16_f32 v88, v86, v87
    v_cvt_pk_bf16_f32 v96, v94, v95
    v_dot2_f32_bf16 v78, v88, v172, v78
    v_dot2_f32_bf16 v79, v96, v172, v79
    v_pk_mul_f32 v[84:85], v[80:81], v[42:43] op_sel_hi:[0,1]
    v_pk_mul_f32 v[92:93], v[80:81], v[42:43] op_sel:[1,0] op_sel_hi:[1,1]
    v_cvt_pk_bf16_f32 v88, v84, v85
    v_lshlrev_b32 v84, 16, v88
    v_and_b32 v85, 0xffff0000, v88
    v_cvt_pk_bf16_f32 v96, v92, v93
    v_lshlrev_b32 v92, 16, v96
    v_and_b32 v93, 0xffff0000, v96
    v_pk_add_f32 v[84:85], v[84:85], v[70:71]
    v_pk_add_f32 v[92:93], v[92:93], v[70:71]
    v_cvt_pk_bf16_f32 v88, v84, v85
    v_lshlrev_b32 v84, 16, v88
    v_and_b32 v85, 0xffff0000, v88
    v_cvt_pk_bf16_f32 v96, v92, v93
    v_lshlrev_b32 v92, 16, v96
    v_and_b32 v93, 0xffff0000, v96
    v_pk_mul_f32 v[86:87], v[84:85], v[84:85]
    v_pk_mul_f32 v[94:95], v[92:93], v[92:93]
    v_pk_fma_f32 v[86:87], v[86:87], v[74:75], v[72:73]
    v_pk_fma_f32 v[94:95], v[94:95], v[74:75], v[72:73]
    v_pk_mul_f32 v[86:87], v[86:87], v[84:85]
    v_pk_mul_f32 v[94:95], v[94:95], v[92:93]
    v_exp_f32 v86, v86
    v_exp_f32 v87, v87
    v_exp_f32 v94, v94
    v_exp_f32 v95, v95
    v_pk_add_f32 v[86:87], v[86:87], v[76:77]
    v_pk_add_f32 v[94:95], v[94:95], v[76:77]
    v_rcp_f32 v86, v86
    v_rcp_f32 v87, v87
    v_rcp_f32 v94, v94
    v_rcp_f32 v95, v95
    v_pk_mul_f32 v[86:87], v[86:87], v[84:85]
    v_pk_mul_f32 v[94:95], v[94:95], v[92:93]
    v_cvt_pk_bf16_f32 v88, v86, v87
    v_cvt_pk_bf16_f32 v96, v94, v95
    v_dot2_f32_bf16 v78, v88, v173, v78
    v_dot2_f32_bf16 v79, v96, v173, v79
    s_nop 3
    s_nop 0
    v_add_f32_dpp v78, v78, v78 quad_perm:[1,0,3,2] row_mask:0xf bank_mask:0xf
    v_add_f32_dpp v79, v79, v79 quad_perm:[1,0,3,2] row_mask:0xf bank_mask:0xf
    s_nop 0
    v_add_f32_dpp v78, v78, v78 quad_perm:[2,3,0,1] row_mask:0xf bank_mask:0xf
    v_add_f32_dpp v79, v79, v79 quad_perm:[2,3,0,1] row_mask:0xf bank_mask:0xf
    s_nop 0
    v_add_f32_dpp v78, v78, v78 row_half_mirror row_mask:0xf bank_mask:0xf
    v_add_f32_dpp v79, v79, v79 row_half_mirror row_mask:0xf bank_mask:0xf
    s_nop 0
    v_add_f32_dpp v78, v78, v78 row_mirror row_mask:0xf bank_mask:0xf
    v_add_f32_dpp v79, v79, v79 row_mirror row_mask:0xf bank_mask:0xf
    v_mov_b32 v84, v78
    v_mov_b32 v85, v79
    s_nop 1
    v_permlane16_swap_b32 v78, v84
    v_permlane16_swap_b32 v79, v85
    s_nop 1
    v_add_f32 v78, v78, v84
    v_add_f32 v79, v79, v85
    v_mov_b32 v84, v78
    v_mov_b32 v85, v79
    s_nop 1
    v_permlane32_swap_b32 v78, v84
    v_permlane32_swap_b32 v79, v85
    s_nop 1
    v_add_f32 v78, v78, v84
    v_add_f32 v79, v79, v85
    v_cvt_pk_bf16_f32 v84, v78, v79
    v_lshlrev_b32 v78, 16, v84
    v_and_b32 v79, 0xffff0000, v84
    v_add_f32 v78, v78, v174
    v_add_f32 v79, v79, v174
    v_cvt_pk_bf16_f32 v84, v78, v79
    v_lshlrev_b32 v78, 16, v84
    v_and_b32 v79, 0xffff0000, v84
    v_add_f32 v78, v78, v82
    v_add_f32 v79, v79, v83
    v_cvt_pk_bf16_f32 v78, v78, v79
    s_mul_i32 s6, s96, 896
    s_mul_i32 s7, s97, 28
    s_add_u32 s6, s6, s7
    s_lshl_b32 s7, s3, 2
    s_add_u32 s6, s6, s7
    v_mov_b32 v5, 0
    s_mov_b64 exec, 1
    buffer_store_dword v78, v5, s[76:79], s6 offen
L_done:
    s_endpgm
.section .rodata,"a"
.p2align 6
.amdhsa_kernel sequential_preLN__gqa_block_cached__mixer_token_mlp__decode_kernel
  .amdhsa_next_free_vgpr 256
  .amdhsa_next_free_sgpr 102
  .amdhsa_accum_offset 256
  .amdhsa_group_segment_fixed_size 0
  .amdhsa_kernarg_size 104
  .amdhsa_user_sgpr_count 2
  .amdhsa_user_sgpr_kernarg_segment_ptr 1
  .amdhsa_system_sgpr_workgroup_id_x 1
.end_amdhsa_kernel
```
